```python
import torch

def _softmax(x, axis=-1):
    return torch.softmax(x, dim=axis)
def _gelu(x):
    return torch.nn.functional.gelu(x, approximate="tanh")
def _silu(x):
    return torch.nn.functional.silu(x)
def _sigmoid(x):
    return torch.sigmoid(x)
def _layernorm(x, axis=-1, eps=1e-5):
    m = x.mean(dim=axis, keepdim=True)
    v = x.var(dim=axis, keepdim=True, unbiased=False)
    return (x - m) / torch.sqrt(v + eps)
def _scatter_add(tgt, idx, src, axis=0):
    return tgt.clone().index_add_(axis, idx, src)
def _segment_sum(src, seg, n):
    out = torch.zeros((n,) + src.shape[1:], dtype=src.dtype)
    return out.index_add_(0, seg, src)
def _pad(x, pw):
    flat = tuple(v for pair in reversed(pw) for v in pair)
    return torch.nn.functional.pad(x, flat)

kernel_name = 'standalone__window_attn_swin_v2__vision'

def setup_inputs():

    _w = (lambda a: (lambda t: t.to(torch.bfloat16) if t.is_floating_point() else t)(torch.as_tensor(a)))
    win = 8
    H = W = (224 // win) * win
    C = 96
    nh = 4
    shift = win // 2
    coords = torch.stack(torch.meshgrid(torch.arange(win), torch.arange(win), indexing="ij"), -1).reshape(-1, 2)
    rel = coords[:, None, :] - coords[None, :, :]
    rel_idx = ((rel[..., 0] + win - 1) * (2 * win - 1) + (rel[..., 1] + win - 1)).to(torch.int64)
    tab = torch.stack(torch.meshgrid(torch.arange(1 - win, win), torch.arange(1 - win, win), indexing="ij"), -1).reshape(-1, 2).to(float)
    tab = (lambda _x: torch.sign(torch.as_tensor(_x)))(tab) * (lambda _x: torch.log1p(torch.as_tensor(_x)))(torch.abs(tab))
    img = torch.zeros((H, W), dtype=torch.int64)
    cnt = 0
    for hs in (slice(0, H - win), slice(H - win, H - shift), slice(H - shift, H)):
        for ws in (slice(0, W - win), slice(W - win, W - shift), slice(W - shift, W)):
            img[hs, ws] = cnt; cnt += 1
    mw = img.reshape(H // win, win, W // win, win).permute(0, 2, 1, 3).reshape(-1, win * win)
    mask = (mw[:, :, None] != mw[:, None, :]).to(float) * (-100.0)
    return {
        "x": _w((lambda *s: torch.randn(*s, dtype=torch.bfloat16) * 0.05)(1, H, W, C)),
        "wqkv": _w((lambda *s: torch.randn(*s, dtype=torch.bfloat16) * 1.6)(C, 3 * C)),
        "wo": _w((lambda *s: torch.randn(*s, dtype=torch.bfloat16) * 0.05)(C, C)),
        "logit_scale": _w((lambda *s: torch.randn(*s, dtype=torch.bfloat16) * 1.6)(nh)),
        "cpb_w1": _w((lambda *s: torch.randn(*s, dtype=torch.bfloat16) * 0.8)(2, 4 * nh)),
        "cpb_w2": _w((lambda *s: torch.randn(*s, dtype=torch.bfloat16) * 0.8)(4 * nh, nh)),
        "rel_coords": _w(tab),
        "rel_idx": _w(rel_idx),
        "attn_mask": _w(mask),
    }

def reference(x, wqkv, wo, logit_scale, cpb_w1, cpb_w2, rel_coords, rel_idx, attn_mask):
    B, H, W, C = x.shape
    win = 8
    nh = 4
    hd = C // nh
    shift = win // 2
    ww = win * win
    nH, nW = H // win, W // win
    xs = torch.roll(x, (-shift, -shift), (1, 2))
    xw = (lambda x, *d: x.permute(*d))(xs.reshape(B, nH, win, nW, win, C), 0, 1, 3, 2, 4, 5).reshape(B * nH * nW, ww, C)
    qkv = (lambda x, *d: x.permute(*d))((xw @ wqkv).reshape(B * nH * nW, ww, 3, nh, hd), 2, 0, 3, 1, 4)
    q, k, v = qkv[0], qkv[1], qkv[2]
    qn = q * (torch.einsum("bhqd,bhqd->bhq", q, q)[..., None] + 1e-12) ** -0.5
    kn = k * (torch.einsum("bhkd,bhkd->bhk", k, k)[..., None] + 1e-12) ** -0.5
    logits = torch.einsum("bhqd,bhkd->bhqk", qn, kn)
    tau = torch.exp(torch.clip(logit_scale, -100.0, 4.6052))
    logits = logits * tau[None, :, None, None]
    hcpb = rel_coords @ cpb_w1
    hcpb = torch.where(hcpb > 0, hcpb, hcpb * 0)
    bias_tab = 16.0 * _sigmoid(hcpb @ cpb_w2)
    bias = (lambda x, *d: x.permute(*d))(bias_tab[rel_idx], 2, 0, 1)
    logits = logits.reshape(B, nH * nW, nh, ww, ww) + bias[None, None, :, :, :] + attn_mask[None, :, None, :, :]
    p = _softmax(logits.reshape(B * nH * nW, nh, ww, ww), axis=-1)
    o = (lambda x, *d: x.permute(*d))(torch.einsum("bhqk,bhkd->bhqd", p, v), 0, 2, 1, 3).reshape(B * nH * nW, ww, C) @ wo
    o = (lambda x, *d: x.permute(*d))(o.reshape(B, nH, nW, win, win, C), 0, 1, 3, 2, 4, 5).reshape(B, H, W, C)
    o = torch.roll(o, (shift, shift), (1, 2))
    return _layernorm(o, axis=-1)
```

```asm
; @launch grid=(256,1,1) block=(768,1,1) lds=145600
.amdgcn_target "amdgcn-amd-amdhsa--gfx950"
.text
.globl standalone__window_attn_swin_v2__vision_kernel
.p2align 8
.type standalone__window_attn_swin_v2__vision_kernel,@function
standalone__window_attn_swin_v2__vision_kernel:
    s_cmp_ge_u32 s2, 256
    s_cbranch_scc1 L_end
    s_load_dwordx8 s[4:11], s[0:1], 0
    s_load_dwordx4 s[12:15], s[0:1], 32
    s_load_dwordx2 s[16:17], s[0:1], 48
    s_load_dwordx2 s[18:19], s[0:1], 72
    v_lshrrev_b32 v164, 6, v0
    v_and_b32 v123, 63, v0
    v_readfirstlane_b32 s3, v164
    v_mul_u32_u24 v165, 0xaaab, v123
    v_lshrrev_b32 v165, 19, v165
    v_mul_u32_u24 v166, 12, v165
    v_sub_u32 v166, v123, v166
    s_lshr_b32 s32, s3, 2
    s_and_b32 s33, s3, 3
    v_mul_u32_u24 v108, 576, v165
    v_lshl_add_u32 v108, v166, 4, v108
    v_lshrrev_b32 v167, 1, v165
    v_xor_b32 v166, v166, v167
    v_mul_u32_u24 v109, 192, v165
    v_lshl_add_u32 v109, v166, 4, v109
    s_add_u32 s41, s2, 6
    s_lshr_b32 s41, s41, 3
    s_add_u32 s42, s2, 5
    s_lshr_b32 s42, s42, 3
    s_min_u32 s42, s42, 23
    s_add_u32 s41, s41, s42
    s_cmp_eq_u32 s32, 0
    s_cselect_b32 s41, s41, 55
    s_lshl_b32 s34, s32, 8
    s_add_u32 s34, s34, s2
    s_add_u32 s34, s34, 16
    s_sub_u32 s34, s34, s41
    s_mul_hi_u32 s35, s34, 0x097b425f
    s_mul_i32 s41, s35, 27
    s_sub_u32 s36, s34, s41
    s_and_b32 s41, s2, 7
    s_sub_u32 s41, s41, 1
    s_lshl_b32 s42, s41, 5
    s_lshr_b32 s53, s2, 3
    s_add_u32 s42, s42, s53
    s_cmp_eq_u32 s32, 0
    s_cselect_b32 s42, s42, -1
    s_cmp_lt_u32 s42, 55
    s_cbranch_scc0 L_int0
    s_sub_u32 s41, s42, 28
    s_cmp_lt_u32 s42, 28
    s_cselect_b32 s35, 27, s41
    s_cselect_b32 s36, s42, 27
L_int0:
    s_lshl_b32 s41, s35, 3
    s_lshl_b32 s42, s33, 1
    s_add_u32 s41, s41, s42
    s_add_u32 s41, s41, 4
    s_sub_u32 s42, s41, 224
    s_cmp_ge_u32 s41, 224
    s_cselect_b32 s41, s42, s41
    s_mul_i32 s37, s41, 43008
    s_mul_i32 s41, s36, 1536
    s_add_u32 s37, s37, s41
    s_add_u32 s37, s37, 768
    s_cmp_eq_u32 s36, 27
    s_cselect_b32 s38, 43008, 0
    s_cselect_b32 s46, 1, 0
    s_cmp_eq_u32 s35, 27
    s_cselect_b32 s45, 1, 0
    s_add_u32 s92, s37, 768
    s_sub_u32 s92, s92, s38
    s_mul_i32 s39, s32, 12288
    s_add_u32 s39, s39, 91072
    s_cmp_eq_u32 s32, 2
    s_cbranch_scc1 L_Cload
    s_cmp_eq_u32 s32, 1
    s_cbranch_scc1 L_common
    s_waitcnt lgkmcnt(0)
    s_mov_b32 s20, s4
    s_and_b32 s21, s5, 0xffff
    s_mov_b32 s22, 9633792
    s_mov_b32 s23, 0x20000
    s_mov_b32 exec_hi, 0xffff
    s_mul_i32 s41, s33, 3072
    s_add_u32 s41, s41, s39
    s_add_u32 m0, s41, 0
    s_nop 0
    buffer_load_dwordx4 v109, s[20:23], s37 offen nt lds
    v_xor_b32 v165, 48, v109
    s_add_u32 m0, s41, 768
    s_nop 0
    buffer_load_dwordx4 v165, s[20:23], s92 offen nt lds
    v_xor_b32 v164, 32, v109
    s_add_u32 s42, s37, 43008
    s_add_u32 m0, s41, 1536
    s_nop 0
    buffer_load_dwordx4 v164, s[20:23], s42 offen nt lds
    v_xor_b32 v165, 16, v109
    s_add_u32 s42, s92, 43008
    s_add_u32 m0, s41, 2304
    s_nop 0
    buffer_load_dwordx4 v165, s[20:23], s42 offen nt lds
    s_mov_b32 s24, s6
    s_and_b32 s25, s7, 0xffff
    s_mov_b32 s26, 55296
    s_mov_b32 s27, 0x20000
    s_mul_i32 s42, s33, 2304
    s_mul_i32 s41, s33, 768
    s_add_u32 s53, s42, 192
    s_add_u32 m0, s41, 64
    s_nop 0
    buffer_load_dwordx4 v108, s[24:27], s53 offen lds
    s_add_u32 s53, s42, 9408
    s_add_u32 m0, s41, 3136
    s_nop 0
    buffer_load_dwordx4 v108, s[24:27], s53 offen lds
    s_add_u32 s53, s42, 18624
    s_add_u32 m0, s41, 6208
    s_nop 0
    buffer_load_dwordx4 v108, s[24:27], s53 offen lds
    s_add_u32 s53, s42, 27840
    s_add_u32 m0, s41, 9280
    s_nop 0
    buffer_load_dwordx4 v108, s[24:27], s53 offen lds
    s_add_u32 s53, s42, 37056
    s_add_u32 m0, s41, 12352
    s_nop 0
    buffer_load_dwordx4 v108, s[24:27], s53 offen lds
    s_add_u32 s53, s42, 46272
    s_add_u32 m0, s41, 15424
    s_nop 0
    buffer_load_dwordx4 v108, s[24:27], s53 offen lds
    s_mov_b64 exec, -1
L_common:
    v_lshlrev_b32 v120, 4, v123
    s_lshl_b32 s40, s32, 2
    v_mov_b32 v161, s40
    s_mov_b32 s96, s33
    s_lshr_b32 s95, s2, 3
    s_and_b32 s95, s95, 15
    s_lshr_b32 s94, s2, 7
    s_and_b32 s41, s2, 7
    s_cmp_eq_u32 s41, 0
    s_cselect_b32 s57, 1, 0
    s_cmp_eq_u32 s32, 0
    s_cselect_b32 s52, s57, 0
    s_cmp_eq_u32 s32, 2
    s_cselect_b32 s97, s57, 0
    v_mov_b32 v119, 0
    v_add_u32 v164, 0, v123
    v_mul_u32_u24 v165, 0xaaab, v164
    v_lshrrev_b32 v165, 19, v165
    v_mul_u32_u24 v166, 12, v165
    v_sub_u32 v166, v164, v166
    v_lshrrev_b32 v167, 1, v165
    v_xor_b32 v167, v167, v165
    v_bfe_u32 v167, v167, 1, 2
    v_xor_b32 v166, v166, v167
    v_lshlrev_b32 v166, 4, v166
    v_lshrrev_b32 v167, 3, v165
    v_mul_u32_u24 v167, 0xa800, v167
    v_add_u32 v166, v166, v167
    v_and_b32 v167, 7, v165
    v_mul_u32_u24 v167, 192, v167
    v_add_u32 v116, v166, v167
    v_bfe_u32 v167, v165, 2, 1
    v_lshlrev_b32 v167, 0, v167
    v_or_b32 v119, v119, v167
    v_add_u32 v164, 64, v123
    v_mul_u32_u24 v165, 0xaaab, v164
    v_lshrrev_b32 v165, 19, v165
    v_mul_u32_u24 v166, 12, v165
    v_sub_u32 v166, v164, v166
    v_lshrrev_b32 v167, 1, v165
    v_xor_b32 v167, v167, v165
    v_bfe_u32 v167, v167, 1, 2
    v_xor_b32 v166, v166, v167
    v_lshlrev_b32 v166, 4, v166
    v_lshrrev_b32 v167, 3, v165
    v_mul_u32_u24 v167, 0xa800, v167
    v_add_u32 v166, v166, v167
    v_and_b32 v167, 7, v165
    v_mul_u32_u24 v167, 192, v167
    v_add_u32 v117, v166, v167
    v_bfe_u32 v167, v165, 2, 1
    v_lshlrev_b32 v167, 1, v167
    v_or_b32 v119, v119, v167
    v_add_u32 v164, 128, v123
    v_mul_u32_u24 v165, 0xaaab, v164
    v_lshrrev_b32 v165, 19, v165
    v_mul_u32_u24 v166, 12, v165
    v_sub_u32 v166, v164, v166
    v_lshrrev_b32 v167, 1, v165
    v_xor_b32 v167, v167, v165
    v_bfe_u32 v167, v167, 1, 2
    v_xor_b32 v166, v166, v167
    v_lshlrev_b32 v166, 4, v166
    v_lshrrev_b32 v167, 3, v165
    v_mul_u32_u24 v167, 0xa800, v167
    v_add_u32 v166, v166, v167
    v_and_b32 v167, 7, v165
    v_mul_u32_u24 v167, 192, v167
    v_add_u32 v118, v166, v167
    v_bfe_u32 v167, v165, 2, 1
    v_lshlrev_b32 v167, 2, v167
    v_or_b32 v119, v119, v167
    v_bfe_i32 v164, v119, 0, 1
    v_and_b32 v164, s38, v164
    v_add_u32 v154, s37, v116
    v_sub_u32 v154, v154, v164
    v_bfe_i32 v164, v119, 1, 1
    v_and_b32 v164, s38, v164
    v_add_u32 v155, s37, v117
    v_sub_u32 v155, v155, v164
    v_bfe_i32 v164, v119, 2, 1
    v_and_b32 v164, s38, v164
    v_add_u32 v156, s37, v118
    v_sub_u32 v156, v156, v164
    v_and_b32 v164, 31, v123
    v_lshrrev_b32 v165, 5, v123
    v_lshrrev_b32 v166, 1, v164
    v_xor_b32 v166, v166, v164
    v_bfe_u32 v166, v166, 1, 2
    v_mul_u32_u24 v167, 192, v164
    v_add_u32 v167, s39, v167
    v_lshl_add_u32 v167, v165, 3, v167
    s_mul_i32 s41, s33, 3
    s_add_u32 s41, s41, 0
    v_xor_b32 v157, s41, v166
    v_lshl_add_u32 v157, v157, 4, v167
    s_mul_i32 s41, s33, 3
    s_add_u32 s41, s41, 1
    v_xor_b32 v158, s41, v166
    v_lshl_add_u32 v158, v158, 4, v167
    s_mul_i32 s41, s33, 3
    s_add_u32 s41, s41, 2
    v_xor_b32 v159, s41, v166
    v_lshl_add_u32 v159, v159, 4, v167
    v_and_b32 v166, 15, v123
    v_mul_u32_u24 v160, 192, v166
    v_lshrrev_b32 v167, 1, v166
    v_xor_b32 v167, v167, v166
    v_bfe_u32 v166, v167, 1, 2
    v_lshrrev_b32 v167, 4, v123
    v_xor_b32 v166, v166, v167
    v_lshl_add_u32 v160, v166, 4, v160
    s_mul_i32 s41, s33, 3072
    s_add_u32 s41, s41, s39
    v_add_u32 v160, s41, v160
    v_and_b32 v166, 7, v164
    v_sub_u32 v166, 7, v166
    v_lshl_add_u32 v166, v165, 2, v166
    v_and_b32 v167, 3, v166
    v_lshlrev_b32 v153, 6, v167
    v_lshrrev_b32 v166, 2, v166
    v_lshl_add_u32 v153, v166, 4, v153
    v_lshrrev_b32 v166, 3, v164
    v_mul_u32_u24 v166, 288, v166
    v_add_u32 v153, v153, v166
    s_mul_i32 s41, s33, 4320
    s_add_u32 s41, s41, 73792
    v_add_u32 v153, s41, v153
    v_bfe_u32 v166, v123, 2, 2
    v_lshl_add_u32 v166, v165, 3, v166
    v_mul_u32_u24 v152, 192, v166
    v_bfe_u32 v166, v123, 4, 1
    v_lshl_add_u32 v152, v166, 5, v152
    v_and_b32 v166, 3, v123
    v_lshl_add_u32 v152, v166, 3, v152
    s_mul_i32 s41, s33, 48
    s_add_u32 s41, s41, 64
    v_add_u32 v152, s41, v152
    v_lshlrev_b32 v162, 4, v123
    v_add_u32 v162, 55360, v162
    v_mov_b32 v124, 0x3f803f80
    v_mov_b32 v125, 0x3f803f80
    v_mov_b32 v126, 0x3f803f80
    v_mov_b32 v127, 0x3f803f80
    v_mov_b32 v128, 0x3f803f80
    v_mov_b32 v129, 0x3f803f80
    v_mov_b32 v130, 0x3f803f80
    v_mov_b32 v131, 0x3f803f80
    v_mov_b32 v132, 0x3f803f80
    v_mov_b32 v133, 0x3f803f80
    v_mov_b32 v134, 0x3f803f80
    v_mov_b32 v135, 0x3f803f80
    v_mov_b32 v136, 0x3f803f80
    v_mov_b32 v137, 0x3f803f80
    v_mov_b32 v138, 0x3f803f80
    v_mov_b32 v139, 0x3f803f80
    s_mov_b32 s48, 0x00ffffff
    s_mov_b32 s49, 0x00ffffff
    s_mov_b32 s58, 0x7fff7fff
    s_mov_b32 s59, 0x7fff7fff
    s_mov_b32 s47, 0x2b0cbccc
    s_waitcnt lgkmcnt(0)
    s_mov_b32 s20, s4
    s_and_b32 s21, s5, 0xffff
    s_mov_b32 s22, 9633792
    s_mov_b32 s23, 0x20000
    s_mov_b32 s24, s6
    s_and_b32 s25, s7, 0xffff
    s_mov_b32 s26, 55296
    s_mov_b32 s27, 0x20000
    s_mov_b32 s28, s18
    s_and_b32 s29, s19, 0xffff
    s_mov_b32 s30, 9633792
    s_mov_b32 s31, 0x20000
    s_load_dwordx2 s[50:51], s[10:11], 0
    s_cmp_eq_u32 s32, 0
    s_cbranch_scc0 L_BC
    s_waitcnt lgkmcnt(0)
    s_cmp_ge_u32 s33, 2
    s_cselect_b32 s41, s51, s50
    s_lshl_b32 s42, s41, 16
    s_and_b32 s41, s41, 0xffff0000
    s_bitcmp1_b32 s33, 0
    s_cselect_b32 s41, s41, s42
    v_mov_b32 v167, s41
    v_min_f32 v167, 0x40930000, v167
    v_max_f32 v167, 0xc2c80000, v167
    v_mul_f32 v167, 0x3fb8aa3b, v167
    v_exp_f32 v167, v167
    s_nop 0
    v_cvt_pk_bf16_f32 v167, v167, v167
    v_lshlrev_b32 v167, 16, v167
    v_mul_f32 v166, 0x3fb8aa3b, v167
    v_cmp_lt_f32 vcc, 0x424ccccd, v166
    v_readfirstlane_b32 s56, v166
    s_cmp_lg_u64 vcc, 0
    s_cselect_b32 s44, 1, 0
    s_cmp_eq_u32 s52, 0
    s_cbranch_scc1 L_A_nopark
    s_and_b32 s53, s33, 1
    s_lshl_b32 s54, s94, 1
    s_add_u32 s53, s53, s54
    s_mov_b32 s35, 0
    s_mov_b32 s36, s95
    s_lshl_b32 s41, s35, 3
    s_lshl_b32 s42, s53, 1
    s_add_u32 s41, s41, s42
    s_add_u32 s41, s41, 4
    s_sub_u32 s42, s41, 224
    s_cmp_ge_u32 s41, 224
    s_cselect_b32 s41, s42, s41
    s_mul_i32 s37, s41, 43008
    s_mul_i32 s41, s36, 1536
    s_add_u32 s37, s37, s41
    s_add_u32 s37, s37, 768
    s_cmp_eq_u32 s36, 27
    s_cselect_b32 s38, 43008, 0
    s_cselect_b32 s46, 1, 0
    s_cmp_eq_u32 s35, 27
    s_cselect_b32 s45, 1, 0
    v_bfe_i32 v164, v119, 0, 1
    v_and_b32 v164, s38, v164
    v_add_u32 v0, s37, v116
    v_sub_u32 v0, v0, v164
    v_bfe_i32 v164, v119, 1, 1
    v_and_b32 v164, s38, v164
    v_add_u32 v1, s37, v117
    v_sub_u32 v1, v1, v164
    v_bfe_i32 v164, v119, 2, 1
    v_and_b32 v164, s38, v164
    v_add_u32 v2, s37, v118
    v_sub_u32 v2, v2, v164
    s_lshl_b32 s41, s33, 10
    s_add_u32 s41, s41, 140224
    v_add_u32 v164, s41, v120
    ds_write_b96 v164, v[0:2]
L_A_nopark:
    v_and_b32 v166, 31, v123
    v_mul_u32_u24 v164, 192, v166
    v_lshrrev_b32 v167, 1, v166
    v_xor_b32 v167, v167, v166
    v_bfe_u32 v167, v167, 1, 2
    v_lshrrev_b32 v166, 5, v123
    v_xor_b32 v166, v166, v167
    v_lshl_add_u32 v164, v166, 4, v164
    v_add_u32 v164, s39, v164
    v_xor_b32 v165, 32, v164
    s_cmp_lg_u32 s3, 0
    s_cbranch_scc1 L_A_nofl
    v_lshlrev_b32 v166, 2, v123
    v_mov_b32 v167, 0
    s_mov_b64 exec, 0xffff
    ds_write_b32 v166, v167 offset:0
    s_mov_b64 exec, -1
L_A_nofl:
    s_waitcnt vmcnt(0) lgkmcnt(0)
    s_barrier
L_main_A:
    s_or_b32 s43, s45, s46
    s_or_b32 s43, s43, s44
    s_setprio 2
    ds_read_b128 v[0:3], v164 offset:0
    ds_read_b128 v[4:7], v164 offset:6144
    ds_read_b64_tr_b16 v[80:81], v152 offset:0
    ds_read_b64_tr_b16 v[82:83], v152 offset:768
    ds_read_b128 v[8:11], v165 offset:0
    ds_read_b128 v[12:15], v165 offset:6144
    ds_read_b64_tr_b16 v[84:85], v152 offset:3072
    ds_read_b64_tr_b16 v[86:87], v152 offset:3840
    ds_read_b128 v[16:19], v164 offset:64
    ds_read_b128 v[20:23], v164 offset:6208
    ds_read_b64_tr_b16 v[88:89], v152 offset:6144
    ds_read_b64_tr_b16 v[90:91], v152 offset:6912
    ds_read_b128 v[24:27], v165 offset:64
    ds_read_b128 v[28:31], v165 offset:6208
    ds_read_b64_tr_b16 v[92:93], v152 offset:9216
    s_waitcnt lgkmcnt(11)
    v_mfma_f32_32x32x16_bf16 v[48:63], v[80:83], v[0:3], 0
    ds_read_b64_tr_b16 v[94:95], v152 offset:9984
    ds_read_b128 v[32:35], v164 offset:128
    ds_read_b128 v[36:39], v164 offset:6272
    v_mfma_f32_32x32x16_bf16 v[64:79], v[80:83], v[4:7], 0
    ds_read_b64_tr_b16 v[96:97], v152 offset:12288
    ds_read_b64_tr_b16 v[98:99], v152 offset:13056
    ds_read_b128 v[40:43], v165 offset:128
    s_waitcnt lgkmcnt(13)
    v_mfma_f32_32x32x16_bf16 v[48:63], v[84:87], v[8:11], v[48:63]
    ds_read_b128 v[44:47], v165 offset:6272
    ds_read_b64_tr_b16 v[100:101], v152 offset:15360
    ds_read_b64_tr_b16 v[102:103], v152 offset:16128
    v_mfma_f32_32x32x16_bf16 v[64:79], v[84:87], v[12:15], v[64:79]
    s_waitcnt lgkmcnt(12)
    v_mfma_f32_32x32x16_bf16 v[48:63], v[88:91], v[16:19], v[48:63]
    v_mfma_f32_32x32x16_bf16 v[64:79], v[88:91], v[20:23], v[64:79]
    s_waitcnt lgkmcnt(8)
    v_mfma_f32_32x32x16_bf16 v[48:63], v[92:95], v[24:27], v[48:63]
    v_mfma_f32_32x32x16_bf16 v[64:79], v[92:95], v[28:31], v[64:79]
    s_waitcnt lgkmcnt(4)
    v_mfma_f32_32x32x16_bf16 v[48:63], v[96:99], v[32:35], v[48:63]
    v_mfma_f32_32x32x16_bf16 v[64:79], v[96:99], v[36:39], v[64:79]
    s_waitcnt lgkmcnt(0)
    v_mfma_f32_32x32x16_bf16 v[48:63], v[100:103], v[40:43], v[48:63]
    v_mfma_f32_32x32x16_bf16 v[64:79], v[100:103], v[44:47], v[64:79]
    s_barrier
L_rest:
    ds_read_b64_tr_b16 v[140:141], v152 offset:18432
    ds_read_b64_tr_b16 v[142:143], v152 offset:19200
    ds_read_b64_tr_b16 v[144:145], v152 offset:21504
    ds_read_b64_tr_b16 v[146:147], v152 offset:22272
    ds_read_b64_tr_b16 v[148:149], v152 offset:24576
    ds_read_b64_tr_b16 v[150:151], v152 offset:25344
    s_nop 3
    v_fma_f32 v166, v48, v48, s47
    v_fma_f32 v167, v64, v64, s47
    v_fmac_f32 v166, v49, v49
    v_fmac_f32 v167, v65, v65
    v_fmac_f32 v166, v50, v50
    v_fmac_f32 v167, v66, v66
    v_fmac_f32 v166, v51, v51
    v_fmac_f32 v167, v67, v67
    v_fmac_f32 v166, v52, v52
    v_fmac_f32 v167, v68, v68
    v_fmac_f32 v166, v53, v53
    v_fmac_f32 v167, v69, v69
    v_fmac_f32 v166, v54, v54
    v_fmac_f32 v167, v70, v70
    v_fmac_f32 v166, v55, v55
    v_fmac_f32 v167, v71, v71
    v_fmac_f32 v166, v56, v56
    v_fmac_f32 v167, v72, v72
    v_fmac_f32 v166, v57, v57
    s_waitcnt lgkmcnt(4)
    v_mfma_f32_32x32x16_bf16 v[80:95], v[140:143], v[0:3], 0
    v_fmac_f32 v167, v73, v73
    v_fmac_f32 v166, v58, v58
    v_fmac_f32 v167, v74, v74
    v_fmac_f32 v166, v59, v59
    v_fmac_f32 v167, v75, v75
    s_mov_b64 exec, 1
    v_mov_b32 v163, 1
    ds_add_u32 v161, v163 offset:16
    s_mov_b64 exec, -1
    v_mfma_f32_32x32x16_bf16 v[96:111], v[140:143], v[4:7], 0
    ds_read_b64_tr_b16 v[140:141], v152 offset:27648
    ds_read_b64_tr_b16 v[142:143], v152 offset:28416
    v_permlane32_swap_b32 v166, v167
    s_waitcnt lgkmcnt(5)
    v_mfma_f32_32x32x16_bf16 v[80:95], v[144:147], v[8:11], v[80:95]
    v_add_f32 v166, v166, v167
    v_rsq_f32 v166, v166
    s_nop 0
    v_mov_b32 v167, v166
    v_mfma_f32_32x32x16_bf16 v[96:111], v[144:147], v[12:15], v[96:111]
    ds_read_b64_tr_b16 v[144:145], v152 offset:30720
    ds_read_b64_tr_b16 v[146:147], v152 offset:31488
    v_permlane32_swap_b32 v166, v167
    s_waitcnt lgkmcnt(5)
    v_mfma_f32_32x32x16_bf16 v[80:95], v[148:151], v[16:19], v[80:95]
    v_mul_f32 v48, v48, v166
    v_mul_f32 v49, v49, v166
    v_mul_f32 v50, v50, v166
    v_mul_f32 v51, v51, v166
    v_mul_f32 v52, v52, v166
    v_mul_f32 v53, v53, v166
    v_mfma_f32_32x32x16_bf16 v[96:111], v[148:151], v[20:23], v[96:111]
    ds_read_b64_tr_b16 v[148:149], v152 offset:33792
    ds_read_b64_tr_b16 v[150:151], v152 offset:34560
    v_mul_f32 v54, v54, v166
    s_waitcnt lgkmcnt(4)
    v_mfma_f32_32x32x16_bf16 v[80:95], v[140:143], v[24:27], v[80:95]
    v_mul_f32 v55, v55, v166
    v_mul_f32 v56, v56, v166
    v_mul_f32 v57, v57, v166
    v_mul_f32 v58, v58, v166
    v_mul_f32 v59, v59, v166
    v_mul_f32 v64, v64, v167
    v_mfma_f32_32x32x16_bf16 v[96:111], v[140:143], v[28:31], v[96:111]
    ds_read_b64_tr_b16 v[140:141], v152 offset:36864
    ds_read_b64_tr_b16 v[142:143], v152 offset:37632
    v_mul_f32 v65, v65, v167
    s_waitcnt lgkmcnt(4)
    v_mfma_f32_32x32x16_bf16 v[80:95], v[144:147], v[32:35], v[80:95]
    v_mul_f32 v66, v66, v167
    v_mul_f32 v67, v67, v167
    v_mul_f32 v68, v68, v167
    v_mul_f32 v69, v69, v167
    v_mul_f32 v70, v70, v167
    v_mul_f32 v71, v71, v167
    v_mfma_f32_32x32x16_bf16 v[96:111], v[144:147], v[36:39], v[96:111]
    ds_read_b64_tr_b16 v[144:145], v152 offset:39936
    ds_read_b64_tr_b16 v[146:147], v152 offset:40704
    v_mul_f32 v72, v72, v167
    s_waitcnt lgkmcnt(4)
    v_mfma_f32_32x32x16_bf16 v[80:95], v[148:151], v[40:43], v[80:95]
    v_mul_f32 v73, v73, v167
    v_mul_f32 v74, v74, v167
    v_mul_f32 v75, v75, v167
    v_cvt_pk_bf16_f32 v112, v48, v49
    v_cvt_pk_bf16_f32 v113, v50, v51
    v_cvt_pk_bf16_f32 v114, v52, v53
    v_mfma_f32_32x32x16_bf16 v[96:111], v[148:151], v[44:47], v[96:111]
    ds_read_b64_tr_b16 v[148:149], v152 offset:43008
    ds_read_b64_tr_b16 v[150:151], v152 offset:43776
    v_cvt_pk_bf16_f32 v115, v54, v55
    v_cvt_pk_bf16_f32 v116, v56, v57
    v_cvt_pk_bf16_f32 v117, v58, v59
    s_waitcnt lgkmcnt(4)
    v_mfma_f32_32x32x16_bf16 v[48:63], v[0:3], v[140:143], 0
    v_cvt_pk_bf16_f32 v118, v64, v65
    v_cvt_pk_bf16_f32 v119, v66, v67
    v_cvt_pk_bf16_f32 v120, v68, v69
    v_cvt_pk_bf16_f32 v121, v70, v71
    v_cvt_pk_bf16_f32 v122, v72, v73
    v_cvt_pk_bf16_f32 v123, v74, v75
    v_mfma_f32_32x32x16_bf16 v[64:79], v[4:7], v[140:143], 0
    ds_read_b64_tr_b16 v[140:141], v152 offset:46080
    ds_read_b64_tr_b16 v[142:143], v152 offset:46848
    v_fma_f32 v92, v80, v80, s47
    s_waitcnt lgkmcnt(4)
    v_mfma_f32_32x32x16_bf16 v[48:63], v[8:11], v[144:147], v[48:63]
    v_fma_f32 v93, v96, v96, s47
    v_fmac_f32 v92, v81, v81
    v_fmac_f32 v93, v97, v97
    v_fmac_f32 v92, v82, v82
    v_fmac_f32 v93, v98, v98
    v_fmac_f32 v92, v83, v83
    v_mfma_f32_32x32x16_bf16 v[64:79], v[12:15], v[144:147], v[64:79]
    ds_read_b64_tr_b16 v[144:145], v152 offset:49152
    ds_read_b64_tr_b16 v[146:147], v152 offset:49920
    v_fmac_f32 v93, v99, v99
    s_waitcnt lgkmcnt(4)
    v_mfma_f32_32x32x16_bf16 v[48:63], v[16:19], v[148:151], v[48:63]
    v_fmac_f32 v92, v84, v84
    v_fmac_f32 v93, v100, v100
    v_fmac_f32 v92, v85, v85
    v_fmac_f32 v93, v101, v101
    v_fmac_f32 v92, v86, v86
    v_fmac_f32 v93, v102, v102
    v_mfma_f32_32x32x16_bf16 v[64:79], v[20:23], v[148:151], v[64:79]
    ds_read_b64_tr_b16 v[148:149], v152 offset:52224
    ds_read_b64_tr_b16 v[150:151], v152 offset:52992
    v_fmac_f32 v92, v87, v87
    s_waitcnt lgkmcnt(4)
    v_mfma_f32_32x32x16_bf16 v[48:63], v[24:27], v[140:143], v[48:63]
    v_fmac_f32 v93, v103, v103
    v_fmac_f32 v92, v88, v88
    v_fmac_f32 v93, v104, v104
    v_fmac_f32 v92, v89, v89
    v_fmac_f32 v93, v105, v105
    v_fmac_f32 v92, v90, v90
    v_mfma_f32_32x32x16_bf16 v[64:79], v[28:31], v[140:143], v[64:79]
    v_fmac_f32 v93, v106, v106
    v_fmac_f32 v92, v91, v91
    v_fmac_f32 v93, v107, v107
    ds_read_b128 v[0:3], v153 offset:2016
    s_nop 0
    v_permlane32_swap_b32 v92, v93
    s_waitcnt lgkmcnt(3)
    v_mfma_f32_32x32x16_bf16 v[64:79], v[36:39], v[144:147], v[64:79]
    v_add_f32 v92, v92, v93
    ds_read_b128 v[4:7], v153 offset:1728
    ds_read_b128 v[8:11], v153 offset:1440
    v_mfma_f32_32x32x16_bf16 v[48:63], v[32:35], v[144:147], v[48:63]
    ds_read_b128 v[12:15], v153 offset:1152
    ds_read_b128 v[16:19], v153 offset:864
    ds_read_b128 v[20:23], v153 offset:576
    s_waitcnt lgkmcnt(6)
    v_mfma_f32_32x32x16_bf16 v[64:79], v[44:47], v[148:151], v[64:79]
    s_cmp_eq_u32 s52, 0
    s_cbranch_scc0 L_pr1
    s_setprio 1
L_pr1:
    ds_read_b128 v[24:27], v153 offset:288
    ds_read_b128 v[28:31], v153 offset:0
    v_mfma_f32_32x32x16_bf16 v[48:63], v[40:43], v[148:151], v[48:63]
    v_rsq_f32 v92, v92
    ds_read_b128 v[108:111], v153 offset:1152
    v_mul_f32 v92, s56, v92
    v_mov_b32 v93, v92
    ds_read_b32 v163, v161 offset:16
    s_nop 0
    v_permlane32_swap_b32 v92, v93
    v_mul_f32 v80, v80, v92
    v_mul_f32 v81, v81, v92
    v_cvt_pk_bf16_f32 v80, v80, v81
    v_mul_f32 v82, v82, v92
    v_mul_f32 v83, v83, v92
    v_cvt_pk_bf16_f32 v81, v82, v83
    v_mul_f32 v84, v84, v92
    v_mul_f32 v85, v85, v92
    v_cvt_pk_bf16_f32 v82, v84, v85
    v_mul_f32 v86, v86, v92
    v_mul_f32 v87, v87, v92
    v_mul_f32 v88, v88, v92
    v_mul_f32 v89, v89, v92
    v_mul_f32 v90, v90, v92
    v_mul_f32 v91, v91, v92
    v_cvt_pk_bf16_f32 v83, v86, v87
    v_cvt_pk_bf16_f32 v84, v88, v89
    v_cvt_pk_bf16_f32 v85, v90, v91
    s_waitcnt lgkmcnt(6)
    v_mfma_f32_32x32x16_bf16 v[0:15], v[112:115], v[80:83], v[0:15]
    v_mul_f32 v96, v96, v93
    v_mul_f32 v97, v97, v93
    v_mul_f32 v98, v98, v93
    v_mul_f32 v99, v99, v93
    v_mul_f32 v100, v100, v93
    v_mul_f32 v101, v101, v93
    s_waitcnt lgkmcnt(2)
    v_mfma_f32_32x32x16_bf16 v[16:31], v[118:121], v[80:83], v[16:31]
    v_mul_f32 v102, v102, v93
    v_mul_f32 v103, v103, v93
    v_mul_f32 v104, v104, v93
    v_mul_f32 v105, v105, v93
    v_mul_f32 v106, v106, v93
    v_mul_f32 v107, v107, v93
    v_mfma_f32_32x32x8_bf16 v[0:15], v[116:117], v[84:85], v[0:15]
    v_cvt_pk_bf16_f32 v86, v96, v97
    v_cvt_pk_bf16_f32 v87, v98, v99
    v_cvt_pk_bf16_f32 v88, v100, v101
    v_cvt_pk_bf16_f32 v89, v102, v103
    v_cvt_pk_bf16_f32 v90, v104, v105
    v_mfma_f32_32x32x8_bf16 v[16:31], v[122:123], v[84:85], v[16:31]
    v_cvt_pk_bf16_f32 v91, v106, v107
    ds_read_b128 v[96:99], v153 offset:2016
    ds_read_b128 v[100:103], v153 offset:1728
    ds_read_b128 v[104:107], v153 offset:1440
    ds_read_b128 v[32:35], v153 offset:3168
    ds_read_b128 v[36:39], v153 offset:2880
    ds_read_b128 v[40:43], v153 offset:2592
    ds_read_b128 v[44:47], v153 offset:2304
    s_waitcnt lgkmcnt(7)
    v_readfirstlane_b32 s41, v163
    s_cmp_lt_u32 s41, 4
    s_cbranch_scc1 L_poll1
L_poll1_ok:
    s_cmp_lg_u32 s43, 0
    s_cbranch_scc1 L_rare0N
L_rare0N_ret:
    v_exp_f32 v0, v0
    v_exp_f32 v1, v1
    s_mov_b64 exec, s[48:49]
    v_cvt_pk_bf16_f32 v124, v48, v49
    v_cvt_pk_bf16_f32 v125, v50, v51
    v_cvt_pk_bf16_f32 v126, v52, v53
    v_cvt_pk_bf16_f32 v127, v54, v55
    v_cvt_pk_bf16_f32 v128, v56, v57
    v_cvt_pk_bf16_f32 v129, v58, v59
    v_cvt_pk_bf16_f32 v130, v60, v61
    v_cvt_pk_bf16_f32 v131, v62, v63
    s_mov_b64 exec, -1
    s_waitcnt lgkmcnt(4)
    v_mfma_f32_32x32x16_bf16 v[96:111], v[118:121], v[86:89], v[96:111]
    v_exp_f32 v2, v2
    v_exp_f32 v3, v3
    v_exp_f32 v4, v4
    v_mfma_f32_32x32x8_bf16 v[96:111], v[122:123], v[90:91], v[96:111]
    v_exp_f32 v5, v5
    v_exp_f32 v6, v6
    v_exp_f32 v7, v7
    s_waitcnt lgkmcnt(0)
    v_mfma_f32_32x32x16_bf16 v[32:47], v[112:115], v[86:89], v[32:47]
    v_cvt_pk_bf16_f32 v0, v0, v1
    v_cvt_pk_bf16_f32 v1, v2, v3
    v_mov_b32 v163, 0
    ds_read_b32 v163, v163 offset:48
    v_mfma_f32_32x32x8_bf16 v[32:47], v[116:117], v[90:91], v[32:47]
    v_cvt_pk_bf16_f32 v2, v4, v5
    v_cvt_pk_bf16_f32 v3, v6, v7
    v_exp_f32 v8, v8
    v_exp_f32 v9, v9
    v_mfma_f32_32x32x16_bf16 v[48:63], v[124:127], v[0:3], 0
    v_exp_f32 v10, v10
    v_exp_f32 v11, v11
    v_exp_f32 v12, v12
    v_exp_f32 v13, v13
    v_exp_f32 v14, v14
    v_exp_f32 v15, v15
    v_cvt_pk_bf16_f32 v4, v8, v9
    v_cvt_pk_bf16_f32 v5, v10, v11
    v_cvt_pk_bf16_f32 v6, v12, v13
    v_cvt_pk_bf16_f32 v7, v14, v15
    v_exp_f32 v16, v16
    s_nop 0
    v_mfma_f32_32x32x16_bf16 v[48:63], v[128:131], v[4:7], v[48:63]
    v_exp_f32 v17, v17
    s_mov_b64 exec, s[48:49]
    v_cvt_pk_bf16_f32 v132, v64, v65
    v_cvt_pk_bf16_f32 v133, v66, v67
    v_cvt_pk_bf16_f32 v134, v68, v69
    v_cvt_pk_bf16_f32 v135, v70, v71
    v_cvt_pk_bf16_f32 v136, v72, v73
    v_cvt_pk_bf16_f32 v137, v74, v75
    v_cvt_pk_bf16_f32 v138, v76, v77
    v_cvt_pk_bf16_f32 v139, v78, v79
    s_mov_b64 exec, -1
    v_exp_f32 v18, v18
    v_exp_f32 v19, v19
    v_exp_f32 v20, v20
    v_exp_f32 v21, v21
    v_exp_f32 v22, v22
    v_exp_f32 v23, v23
    v_cvt_pk_bf16_f32 v16, v16, v17
    v_cvt_pk_bf16_f32 v17, v18, v19
    v_cvt_pk_bf16_f32 v18, v20, v21
    v_cvt_pk_bf16_f32 v19, v22, v23
    v_exp_f32 v24, v24
    s_nop 0
    v_mfma_f32_32x32x16_bf16 v[48:63], v[132:135], v[16:19], v[48:63]
    v_exp_f32 v25, v25
    v_exp_f32 v26, v26
    v_exp_f32 v27, v27
    v_exp_f32 v28, v28
    v_exp_f32 v29, v29
    v_exp_f32 v30, v30
    v_exp_f32 v31, v31
    v_cvt_pk_bf16_f32 v20, v24, v25
    v_cvt_pk_bf16_f32 v21, v26, v27
    v_cvt_pk_bf16_f32 v22, v28, v29
    v_cvt_pk_bf16_f32 v23, v30, v31
    s_nop 1
    v_mfma_f32_32x32x16_bf16 v[48:63], v[136:139], v[20:23], v[48:63]
    s_cmp_eq_u32 s52, 0
    s_cbranch_scc0 L_pr2
    s_setprio 1
L_pr2:
    s_waitcnt lgkmcnt(0)
    v_readfirstlane_b32 s41, v163
    s_cmp_lt_u32 s41, 4
    s_cbranch_scc1 L_poll2
L_poll2_ok:
    s_cmp_lg_u32 s43, 0
    s_cbranch_scc1 L_rare1N
L_rare1N_ret:
    v_exp_f32 v32, v32
    v_exp_f32 v33, v33
    v_exp_f32 v34, v34
    v_exp_f32 v35, v35
    v_exp_f32 v36, v36
    v_exp_f32 v37, v37
    v_exp_f32 v38, v38
    v_exp_f32 v39, v39
    v_cvt_pk_bf16_f32 v32, v32, v33
    v_cvt_pk_bf16_f32 v33, v34, v35
    v_cvt_pk_bf16_f32 v34, v36, v37
    v_cvt_pk_bf16_f32 v35, v38, v39
    v_exp_f32 v40, v40
    s_nop 0
    v_mfma_f32_32x32x16_bf16 v[64:79], v[124:127], v[32:35], 0
    v_exp_f32 v41, v41
    v_exp_f32 v42, v42
    v_exp_f32 v43, v43
    v_exp_f32 v44, v44
    v_exp_f32 v45, v45
    v_exp_f32 v46, v46
    v_exp_f32 v47, v47
    v_cvt_pk_bf16_f32 v36, v40, v41
    v_cvt_pk_bf16_f32 v37, v42, v43
    v_cvt_pk_bf16_f32 v38, v44, v45
    v_cvt_pk_bf16_f32 v39, v46, v47
    v_exp_f32 v96, v96
    s_nop 0
    v_mfma_f32_32x32x16_bf16 v[64:79], v[128:131], v[36:39], v[64:79]
    v_exp_f32 v97, v97
    v_exp_f32 v98, v98
    v_exp_f32 v99, v99
    v_exp_f32 v100, v100
    v_exp_f32 v101, v101
    v_exp_f32 v102, v102
    v_exp_f32 v103, v103
    v_cvt_pk_bf16_f32 v96, v96, v97
    v_cvt_pk_bf16_f32 v97, v98, v99
    v_cvt_pk_bf16_f32 v98, v100, v101
    v_cvt_pk_bf16_f32 v99, v102, v103
    v_exp_f32 v104, v104
    s_nop 0
    v_mfma_f32_32x32x16_bf16 v[64:79], v[132:135], v[96:99], v[64:79]
    v_exp_f32 v105, v105
    v_exp_f32 v106, v106
    v_exp_f32 v107, v107
    v_exp_f32 v108, v108
    v_exp_f32 v109, v109
    v_exp_f32 v110, v110
    v_exp_f32 v111, v111
    v_cvt_pk_bf16_f32 v100, v104, v105
    v_cvt_pk_bf16_f32 v101, v106, v107
    v_cvt_pk_bf16_f32 v102, v108, v109
    v_cvt_pk_bf16_f32 v103, v110, v111
    v_rcp_f32 v166, v60
    s_nop 0
    v_mfma_f32_32x32x16_bf16 v[64:79], v[136:139], v[100:103], v[64:79]
    s_cmp_eq_u32 s52, 0
    s_cbranch_scc0 L_pr3
    s_setprio 0
L_pr3:
    v_mul_f32 v48, v48, v166
    v_mul_f32 v49, v49, v166
    v_cvt_pk_bf16_f32 v48, v48, v49
    v_mul_f32 v50, v50, v166
    v_mul_f32 v51, v51, v166
    v_cvt_pk_bf16_f32 v49, v50, v51
    v_mul_f32 v52, v52, v166
    v_mul_f32 v53, v53, v166
    s_nop 0
    v_rcp_f32 v167, v76
    v_cvt_pk_bf16_f32 v50, v52, v53
    v_mul_f32 v64, v64, v167
    v_mul_f32 v65, v65, v167
    v_cvt_pk_bf16_f32 v64, v64, v65
    v_mul_f32 v66, v66, v167
    v_mul_f32 v67, v67, v167
    v_cvt_pk_bf16_f32 v65, v66, v67
    v_mul_f32 v68, v68, v167
    v_mul_f32 v69, v69, v167
    v_cvt_pk_bf16_f32 v66, v68, v69
    v_mul_f32 v54, v54, v166
    v_mul_f32 v55, v55, v166
    v_mul_f32 v56, v56, v166
    v_mul_f32 v57, v57, v166
    v_mul_f32 v58, v58, v166
    v_mul_f32 v59, v59, v166
    v_mul_f32 v70, v70, v167
    v_mul_f32 v71, v71, v167
    v_mul_f32 v72, v72, v167
    v_mul_f32 v73, v73, v167
    v_mul_f32 v74, v74, v167
    v_mul_f32 v75, v75, v167
    v_cvt_pk_bf16_f32 v51, v54, v55
    v_cvt_pk_bf16_f32 v52, v56, v57
    v_cvt_pk_bf16_f32 v53, v58, v59
    v_cvt_pk_bf16_f32 v67, v70, v71
    v_cvt_pk_bf16_f32 v68, v72, v73
    v_cvt_pk_bf16_f32 v69, v74, v75
    ds_write_b64 v157, v[48:49] offset:0
    ds_write_b64 v158, v[50:51] offset:0
    ds_write_b64 v159, v[52:53] offset:0
    ds_write_b64 v157, v[64:65] offset:6144
    ds_write_b64 v158, v[66:67] offset:6144
    ds_write_b64 v159, v[68:69] offset:6144
    s_mov_b64 exec, 1
    v_mov_b32 v163, 1
    ds_add_u32 v161, v163 offset:32
    s_mov_b64 exec, -1
    ds_read_b32 v163, v161 offset:32
    ds_read_b128 v[112:115], v162 offset:0
    ds_read_b128 v[80:83], v162 offset:1024
    ds_read_b128 v[116:119], v162 offset:6144
    ds_read_b128 v[140:143], v162 offset:2048
    ds_read_b128 v[84:87], v162 offset:7168
    ds_read_b128 v[0:3], v162 offset:3072
    ds_read_b128 v[120:123], v162 offset:12288
    ds_read_b128 v[144:147], v162 offset:8192
    ds_read_b128 v[12:15], v162 offset:4096
    ds_read_b128 v[88:91], v162 offset:13312
    ds_read_b128 v[4:7], v162 offset:9216
    s_waitcnt lgkmcnt(11)
    v_readfirstlane_b32 s41, v163
    s_cmp_lt_u32 s41, 4
    s_cbranch_scc1 L_poll3
L_poll3_ok:
    ds_read_b128 v[36:39], v160 offset:0
    ds_read_b128 v[40:43], v160 offset:64
    ds_read_b128 v[44:47], v160 offset:128
    ds_read_b128 v[24:27], v162 offset:5120
    ds_read_b128 v[148:151], v162 offset:14336
    ds_read_b128 v[16:19], v162 offset:10240
    ds_read_b128 v[8:11], v162 offset:15360
    ds_read_b128 v[28:31], v162 offset:11264
    ds_read_b128 v[20:23], v162 offset:16384
    ds_read_b128 v[32:35], v162 offset:17408
    v_mov_b32 v76, 0x3c2aaaab
    s_mul_i32 s53, s96, 3072
    s_add_u32 s53, s53, s39
    s_sub_u32 s53, s53, 55360
    v_add_u32 v164, s53, v162
    s_waitcnt lgkmcnt(9)
    v_mfma_f32_16x16x32_bf16 v[48:51], v[112:115], v[36:39], 0
    v_mfma_f32_16x16x32_bf16 v[52:55], v[80:83], v[36:39], 0
    s_waitcnt lgkmcnt(8)
    v_mfma_f32_16x16x32_bf16 v[48:51], v[116:119], v[40:43], v[48:51]
    v_mfma_f32_16x16x32_bf16 v[56:59], v[140:143], v[36:39], 0
    v_mfma_f32_16x16x32_bf16 v[52:55], v[84:87], v[40:43], v[52:55]
    v_mfma_f32_16x16x32_bf16 v[60:63], v[0:3], v[36:39], 0
    s_waitcnt lgkmcnt(7)
    v_mfma_f32_16x16x32_bf16 v[48:51], v[120:123], v[44:47], v[48:51]
    v_mfma_f32_16x16x32_bf16 v[56:59], v[144:147], v[40:43], v[56:59]
    v_mfma_f32_16x16x32_bf16 v[64:67], v[12:15], v[36:39], 0
    s_nop 5
    v_mul_f32 v74, v48, v48
    v_mul_f32 v75, v49, v49
    v_mfma_f32_16x16x32_bf16 v[52:55], v[88:91], v[44:47], v[52:55]
    v_fmac_f32 v74, v50, v50
    v_fmac_f32 v75, v51, v51
    v_mfma_f32_16x16x32_bf16 v[60:63], v[4:7], v[40:43], v[60:63]
    s_waitcnt lgkmcnt(6)
    v_mfma_f32_16x16x32_bf16 v[68:71], v[24:27], v[36:39], 0
    s_nop 2
    v_fmac_f32 v74, v52, v52
    v_fmac_f32 v75, v53, v53
    s_waitcnt lgkmcnt(5)
    v_mfma_f32_16x16x32_bf16 v[56:59], v[148:151], v[44:47], v[56:59]
    v_fmac_f32 v74, v54, v54
    v_fmac_f32 v75, v55, v55
    s_waitcnt lgkmcnt(4)
    v_mfma_f32_16x16x32_bf16 v[64:67], v[16:19], v[40:43], v[64:67]
    s_waitcnt lgkmcnt(3)
    v_mfma_f32_16x16x32_bf16 v[60:63], v[8:11], v[44:47], v[60:63]
    s_nop 1
    v_fmac_f32 v74, v56, v56
    v_fmac_f32 v75, v57, v57
    s_waitcnt lgkmcnt(2)
    v_mfma_f32_16x16x32_bf16 v[68:71], v[28:31], v[40:43], v[68:71]
    v_fmac_f32 v74, v58, v58
    v_fmac_f32 v75, v59, v59
    s_waitcnt lgkmcnt(1)
    v_mfma_f32_16x16x32_bf16 v[64:67], v[20:23], v[44:47], v[64:67]
    v_fmac_f32 v74, v60, v60
    v_fmac_f32 v75, v61, v61
    s_waitcnt lgkmcnt(0)
    v_mfma_f32_16x16x32_bf16 v[68:71], v[32:35], v[44:47], v[68:71]
    v_fmac_f32 v74, v62, v62
    v_fmac_f32 v75, v63, v63
    s_nop 1
    v_fmac_f32 v74, v64, v64
    v_fmac_f32 v75, v65, v65
    v_fmac_f32 v74, v66, v66
    v_fmac_f32 v75, v67, v67
    v_fmac_f32 v74, v68, v68
    v_fmac_f32 v75, v69, v69
    v_fmac_f32 v74, v70, v70
    v_fmac_f32 v75, v71, v71
    v_add_f32 v74, v74, v75
    s_nop 1
    v_mfma_f32_16x16x4_f32 v[84:87], v76, v74, 0
    s_nop 9
    v_add_f32 v74, 0x3727c5ac, v84
    v_rsq_f32 v74, v74
    s_nop 0
    v_mul_f32 v48, v48, v74
    v_mul_f32 v49, v49, v74
    v_cvt_pk_bf16_f32 v48, v48, v49
    v_mul_f32 v50, v50, v74
    v_mul_f32 v51, v51, v74
    v_cvt_pk_bf16_f32 v49, v50, v51
    v_mul_f32 v52, v52, v74
    v_mul_f32 v53, v53, v74
    v_mul_f32 v54, v54, v74
    v_mul_f32 v55, v55, v74
    v_mul_f32 v56, v56, v74
    v_mul_f32 v57, v57, v74
    v_cvt_pk_bf16_f32 v50, v52, v53
    v_cvt_pk_bf16_f32 v51, v54, v55
    v_cvt_pk_bf16_f32 v56, v56, v57
    v_mul_f32 v58, v58, v74
    v_mul_f32 v59, v59, v74
    ds_write_b128 v160, v[48:51] offset:0
    v_cvt_pk_bf16_f32 v57, v58, v59
    v_mul_f32 v60, v60, v74
    v_mul_f32 v61, v61, v74
    v_mul_f32 v62, v62, v74
    v_mul_f32 v63, v63, v74
    v_mul_f32 v64, v64, v74
    v_mul_f32 v65, v65, v74
    v_cvt_pk_bf16_f32 v58, v60, v61
    v_cvt_pk_bf16_f32 v59, v62, v63
    v_cvt_pk_bf16_f32 v64, v64, v65
    v_mul_f32 v66, v66, v74
    v_mul_f32 v67, v67, v74
    ds_write_b128 v160, v[56:59] offset:64
    v_cvt_pk_bf16_f32 v65, v66, v67
    v_mul_f32 v68, v68, v74
    v_mul_f32 v69, v69, v74
    v_mul_f32 v70, v70, v74
    v_mul_f32 v71, v71, v74
    v_cvt_pk_bf16_f32 v66, v68, v69
    v_cvt_pk_bf16_f32 v67, v70, v71
    ds_write_b128 v160, v[64:67] offset:128
    ds_read_b128 v[0:3], v164 offset:0
    ds_read_b128 v[4:7], v164 offset:1024
    ds_read_b128 v[8:11], v164 offset:2048
    s_waitcnt lgkmcnt(2)
    buffer_store_dwordx4 v[0:3], v154, s[28:31], 0 offen sc0 sc1
    s_waitcnt lgkmcnt(1)
    buffer_store_dwordx4 v[4:7], v155, s[28:31], 0 offen sc0 sc1
    s_waitcnt lgkmcnt(0)
    buffer_store_dwordx4 v[8:11], v156, s[28:31], 0 offen sc0 sc1
    s_cmp_eq_u32 s52, 0
    s_cbranch_scc1 L_fin
    v_mbcnt_lo_u32_b32 v123, -1, 0
    v_mbcnt_hi_u32_b32 v123, -1, v123
    s_lshl_b32 s41, s33, 10
    s_add_u32 s41, s41, 140224
    v_lshlrev_b32 v164, 4, v123
    v_add_u32 v164, s41, v164
    s_nop 1
    ds_read_b96 v[154:156], v164
    s_add_u32 s39, s39, 36864
    s_mov_b32 s40, 12
    v_mov_b32 v161, 12
    s_mov_b32 s45, 0
    s_mov_b32 s46, 0
    s_lshl_b32 s96, s94, 1
    s_add_u32 s96, s96, s33
    s_mul_i32 s53, s94, 6144
    s_add_u32 s54, s53, 36864
    v_add_u32 v157, s54, v157
    v_add_u32 v158, s54, v158
    v_add_u32 v159, s54, v159
    v_add_u32 v160, s54, v160
    v_and_b32 v166, 31, v123
    v_mul_u32_u24 v164, 192, v166
    v_lshrrev_b32 v167, 1, v166
    v_xor_b32 v167, v167, v166
    v_bfe_u32 v167, v167, 1, 2
    v_lshrrev_b32 v166, 5, v123
    v_xor_b32 v166, v166, v167
    v_lshl_add_u32 v164, v166, 4, v164
    v_add_u32 v164, s39, v164
    v_xor_b32 v165, 32, v164
    s_sub_u32 s54, 6144, s53
    v_add_u32 v166, s54, v164
    v_add_u32 v167, s54, v165
    v_add_u32 v164, s53, v164
    v_add_u32 v165, s53, v165
    s_waitcnt lgkmcnt(0)
L_main_H:
    s_or_b32 s43, s45, s46
    s_or_b32 s43, s43, s44
    s_setprio 0
    ds_read_b64_tr_b16 v[80:81], v152 offset:0
    ds_read_b64_tr_b16 v[82:83], v152 offset:768
    ds_read_b64_tr_b16 v[84:85], v152 offset:3072
    ds_read_b64_tr_b16 v[86:87], v152 offset:3840
    ds_read_b64_tr_b16 v[88:89], v152 offset:6144
    ds_read_b64_tr_b16 v[90:91], v152 offset:6912
    ds_read_b64_tr_b16 v[92:93], v152 offset:9216
    ds_read_b64_tr_b16 v[94:95], v152 offset:9984
    ds_read_b64_tr_b16 v[96:97], v152 offset:12288
    ds_read_b64_tr_b16 v[98:99], v152 offset:13056
    ds_read_b64_tr_b16 v[100:101], v152 offset:15360
    ds_read_b64_tr_b16 v[102:103], v152 offset:16128
    ds_read_b32 v163, v161 offset:0
    s_waitcnt lgkmcnt(0)
    v_readfirstlane_b32 s41, v163
    s_cmp_lt_u32 s41, 4
    s_cbranch_scc1 L_poll4
L_poll4_ok:
    ds_read_b128 v[0:3], v164 offset:0
    ds_read_b128 v[4:7], v166 offset:0
    ds_read_b128 v[8:11], v165 offset:0
    ds_read_b128 v[12:15], v167 offset:0
    ds_read_b128 v[16:19], v164 offset:64
    ds_read_b128 v[20:23], v166 offset:64
    ds_read_b128 v[24:27], v165 offset:64
    ds_read_b128 v[28:31], v167 offset:64
    ds_read_b128 v[32:35], v164 offset:128
    ds_read_b128 v[36:39], v166 offset:128
    ds_read_b128 v[40:43], v165 offset:128
    ds_read_b128 v[44:47], v167 offset:128
    s_waitcnt lgkmcnt(11)
    v_mfma_f32_32x32x16_bf16 v[48:63], v[80:83], v[0:3], 0
    s_waitcnt lgkmcnt(10)
    v_mfma_f32_32x32x16_bf16 v[64:79], v[80:83], v[4:7], 0
    s_waitcnt lgkmcnt(9)
    v_mfma_f32_32x32x16_bf16 v[48:63], v[84:87], v[8:11], v[48:63]
    s_waitcnt lgkmcnt(8)
    v_mfma_f32_32x32x16_bf16 v[64:79], v[84:87], v[12:15], v[64:79]
    s_waitcnt lgkmcnt(7)
    v_mfma_f32_32x32x16_bf16 v[48:63], v[88:91], v[16:19], v[48:63]
    s_waitcnt lgkmcnt(6)
    v_mfma_f32_32x32x16_bf16 v[64:79], v[88:91], v[20:23], v[64:79]
    s_waitcnt lgkmcnt(5)
    v_mfma_f32_32x32x16_bf16 v[48:63], v[92:95], v[24:27], v[48:63]
    s_waitcnt lgkmcnt(4)
    v_mfma_f32_32x32x16_bf16 v[64:79], v[92:95], v[28:31], v[64:79]
    s_waitcnt lgkmcnt(3)
    v_mfma_f32_32x32x16_bf16 v[48:63], v[96:99], v[32:35], v[48:63]
    s_waitcnt lgkmcnt(2)
    v_mfma_f32_32x32x16_bf16 v[64:79], v[96:99], v[36:39], v[64:79]
    s_waitcnt lgkmcnt(1)
    v_mfma_f32_32x32x16_bf16 v[48:63], v[100:103], v[40:43], v[48:63]
    s_waitcnt lgkmcnt(0)
    v_mfma_f32_32x32x16_bf16 v[64:79], v[100:103], v[44:47], v[64:79]
    ds_read_b64_tr_b16 v[140:141], v152 offset:18432
    ds_read_b64_tr_b16 v[142:143], v152 offset:19200
    ds_read_b64_tr_b16 v[144:145], v152 offset:21504
    ds_read_b64_tr_b16 v[146:147], v152 offset:22272
    ds_read_b64_tr_b16 v[148:149], v152 offset:24576
    ds_read_b64_tr_b16 v[150:151], v152 offset:25344
    s_nop 3
    v_fma_f32 v166, v48, v48, s47
    s_nop 0
    v_fma_f32 v167, v64, v64, s47
    v_fmac_f32 v166, v49, v49
    v_fmac_f32 v167, v65, v65
    v_fmac_f32 v166, v50, v50
    v_fmac_f32 v167, v66, v66
    v_fmac_f32 v166, v51, v51
    v_fmac_f32 v167, v67, v67
    v_fmac_f32 v166, v52, v52
    v_fmac_f32 v167, v68, v68
    v_fmac_f32 v166, v53, v53
    v_fmac_f32 v167, v69, v69
    v_fmac_f32 v166, v54, v54
    v_fmac_f32 v167, v70, v70
    v_fmac_f32 v166, v55, v55
    v_fmac_f32 v167, v71, v71
    v_fmac_f32 v166, v56, v56
    v_fmac_f32 v167, v72, v72
    v_fmac_f32 v166, v57, v57
    s_waitcnt lgkmcnt(4)
    v_mfma_f32_32x32x16_bf16 v[80:95], v[140:143], v[0:3], 0
    ds_read_b64_tr_b16 v[140:141], v152 offset:27648
    ds_read_b64_tr_b16 v[142:143], v152 offset:28416
    v_fmac_f32 v167, v73, v73
    s_waitcnt lgkmcnt(4)
    v_mfma_f32_32x32x16_bf16 v[80:95], v[144:147], v[8:11], v[80:95]
    ds_read_b64_tr_b16 v[144:145], v152 offset:30720
    ds_read_b64_tr_b16 v[146:147], v152 offset:31488
    v_fmac_f32 v166, v58, v58
    s_waitcnt lgkmcnt(4)
    v_mfma_f32_32x32x16_bf16 v[80:95], v[148:151], v[16:19], v[80:95]
    ds_read_b64_tr_b16 v[148:149], v152 offset:33792
    ds_read_b64_tr_b16 v[150:151], v152 offset:34560
    v_fmac_f32 v167, v74, v74
    v_fmac_f32 v166, v59, v59
    v_fmac_f32 v167, v75, v75
    s_mov_b64 exec, 1
    v_mov_b32 v163, 1
    ds_add_u32 v161, v163 offset:16
    s_mov_b64 exec, -1
    v_permlane32_swap_b32 v166, v167
    v_add_f32 v166, v166, v167
    v_rsq_f32 v166, v166
    s_waitcnt lgkmcnt(5)
    v_mfma_f32_32x32x16_bf16 v[80:95], v[140:143], v[24:27], v[80:95]
    ds_read_b64_tr_b16 v[140:141], v152 offset:36864
    ds_read_b64_tr_b16 v[142:143], v152 offset:37632
    v_mov_b32 v167, v166
    s_waitcnt lgkmcnt(5)
    v_mfma_f32_32x32x16_bf16 v[80:95], v[144:147], v[32:35], v[80:95]
    ds_read_b64_tr_b16 v[144:145], v152 offset:39936
    ds_read_b64_tr_b16 v[146:147], v152 offset:40704
    v_permlane32_swap_b32 v166, v167
    s_waitcnt lgkmcnt(5)
    v_mfma_f32_32x32x16_bf16 v[80:95], v[148:151], v[40:43], v[80:95]
    ds_read_b64_tr_b16 v[148:149], v152 offset:43008
    ds_read_b64_tr_b16 v[150:151], v152 offset:43776
    v_mul_f32 v48, v48, v166
    v_mul_f32 v49, v49, v166
    v_mul_f32 v50, v50, v166
    v_mul_f32 v51, v51, v166
    v_mul_f32 v52, v52, v166
    v_mul_f32 v53, v53, v166
    v_mul_f32 v54, v54, v166
    v_mul_f32 v55, v55, v166
    v_mul_f32 v56, v56, v166
    v_mul_f32 v57, v57, v166
    v_mul_f32 v58, v58, v166
    v_mul_f32 v59, v59, v166
    v_mul_f32 v64, v64, v167
    v_mul_f32 v65, v65, v167
    v_mul_f32 v66, v66, v167
    v_mul_f32 v67, v67, v167
    v_mul_f32 v68, v68, v167
    v_mul_f32 v69, v69, v167
    v_mul_f32 v70, v70, v167
    v_mul_f32 v71, v71, v167
    v_mul_f32 v72, v72, v167
    v_mul_f32 v73, v73, v167
    v_mul_f32 v74, v74, v167
    v_mul_f32 v75, v75, v167
    v_cvt_pk_bf16_f32 v112, v48, v49
    v_cvt_pk_bf16_f32 v113, v50, v51
    v_cvt_pk_bf16_f32 v114, v52, v53
    v_cvt_pk_bf16_f32 v115, v54, v55
    v_cvt_pk_bf16_f32 v116, v56, v57
    v_cvt_pk_bf16_f32 v117, v58, v59
    s_waitcnt lgkmcnt(4)
    v_mfma_f32_32x32x16_bf16 v[48:63], v[0:3], v[140:143], 0
    v_cvt_pk_bf16_f32 v118, v64, v65
    v_cvt_pk_bf16_f32 v119, v66, v67
    v_cvt_pk_bf16_f32 v120, v68, v69
    v_cvt_pk_bf16_f32 v121, v70, v71
    v_cvt_pk_bf16_f32 v122, v72, v73
    s_waitcnt lgkmcnt(2)
    v_mfma_f32_32x32x16_bf16 v[48:63], v[8:11], v[144:147], v[48:63]
    v_cvt_pk_bf16_f32 v123, v74, v75
    s_mul_i32 s53, s94, 2304
    v_add_u32 v94, s53, v153
    ds_read_b128 v[0:3], v153 offset:2016
    v_mfma_f32_32x32x16_bf16 v[64:79], v[4:7], v[140:143], 0
    ds_read_b64_tr_b16 v[140:141], v152 offset:46080
    ds_read_b64_tr_b16 v[142:143], v152 offset:46848
    ds_read_b128 v[4:7], v153 offset:1728
    v_mfma_f32_32x32x16_bf16 v[64:79], v[12:15], v[144:147], v[64:79]
    ds_read_b64_tr_b16 v[144:145], v152 offset:49152
    ds_read_b64_tr_b16 v[146:147], v152 offset:49920
    ds_read_b128 v[8:11], v153 offset:1440
    s_waitcnt lgkmcnt(7)
    v_mfma_f32_32x32x16_bf16 v[48:63], v[16:19], v[148:151], v[48:63]
    ds_read_b128 v[12:15], v153 offset:1152
    ds_read_b128 v[16:19], v94 offset:864
    v_fma_f32 v92, v80, v80, s47
    v_mfma_f32_32x32x16_bf16 v[64:79], v[20:23], v[148:151], v[64:79]
    ds_read_b64_tr_b16 v[148:149], v152 offset:52224
    ds_read_b64_tr_b16 v[150:151], v152 offset:52992
    ds_read_b128 v[20:23], v94 offset:576
    s_waitcnt lgkmcnt(9)
    v_mfma_f32_32x32x16_bf16 v[48:63], v[24:27], v[140:143], v[48:63]
    ds_read_b128 v[24:27], v94 offset:288
    v_mul_f32 v93, v81, v81
    v_fmac_f32 v92, v82, v82
    v_fmac_f32 v93, v83, v83
    v_fmac_f32 v92, v84, v84
    v_mfma_f32_32x32x16_bf16 v[64:79], v[28:31], v[140:143], v[64:79]
    ds_read_b128 v[28:31], v94 offset:0
    v_fmac_f32 v93, v85, v85
    v_fmac_f32 v92, v86, v86
    v_fmac_f32 v93, v87, v87
    v_fmac_f32 v92, v88, v88
    s_waitcnt lgkmcnt(8)
    v_mfma_f32_32x32x16_bf16 v[64:79], v[36:39], v[144:147], v[64:79]
    v_fmac_f32 v93, v89, v89
    v_fmac_f32 v92, v90, v90
    v_fmac_f32 v93, v91, v91
    v_add_f32 v92, v92, v93
    v_mov_b32 v93, v92
    ds_read_b128 v[140:143], v162 offset:2048
    s_waitcnt lgkmcnt(4)
    v_mfma_f32_32x32x16_bf16 v[64:79], v[44:47], v[148:151], v[64:79]
    s_setprio 0
    ds_read_b32 v163, v161 offset:16
    v_permlane32_swap_b32 v92, v93
    v_add_f32 v92, v92, v93
    v_mfma_f32_32x32x16_bf16 v[48:63], v[32:35], v[144:147], v[48:63]
    v_rsq_f32 v92, v92
    ds_read_b128 v[144:147], v162 offset:8192
    v_mul_f32 v92, s56, v92
    v_mul_f32 v80, v80, v92
    v_mfma_f32_32x32x16_bf16 v[48:63], v[40:43], v[148:151], v[48:63]
    v_mul_f32 v81, v81, v92
    v_cvt_pk_bf16_f32 v80, v80, v81
    v_mul_f32 v82, v82, v92
    v_mul_f32 v83, v83, v92
    v_cvt_pk_bf16_f32 v81, v82, v83
    v_mul_f32 v84, v84, v92
    v_mul_f32 v85, v85, v92
    v_mul_f32 v86, v86, v92
    v_mul_f32 v87, v87, v92
    v_cvt_pk_bf16_f32 v82, v84, v85
    v_cvt_pk_bf16_f32 v83, v86, v87
    v_mul_f32 v88, v88, v92
    v_mul_f32 v89, v89, v92
    v_mfma_f32_32x32x16_bf16 v[0:15], v[112:115], v[80:83], v[0:15]
    v_mul_f32 v90, v90, v92
    v_mul_f32 v91, v91, v92
    v_cvt_pk_bf16_f32 v84, v88, v89
    v_cvt_pk_bf16_f32 v85, v90, v91
    s_waitcnt lgkmcnt(1)
    v_readfirstlane_b32 s41, v163
    s_cmp_lt_u32 s41, 4
    s_cbranch_scc1 L_poll5
L_poll5_ok:
    v_mfma_f32_32x32x16_bf16 v[16:31], v[118:121], v[80:83], v[16:31]
    s_mov_b64 exec, s[48:49]
    v_cvt_pk_bf16_f32 v124, v48, v49
    v_cvt_pk_bf16_f32 v125, v50, v51
    v_cvt_pk_bf16_f32 v126, v52, v53
    v_cvt_pk_bf16_f32 v127, v54, v55
    v_cvt_pk_bf16_f32 v128, v56, v57
    v_cvt_pk_bf16_f32 v129, v58, v59
    v_cvt_pk_bf16_f32 v130, v60, v61
    v_cvt_pk_bf16_f32 v131, v62, v63
    s_mov_b64 exec, -1
    v_mfma_f32_32x32x8_bf16 v[0:15], v[116:117], v[84:85], v[0:15]
    s_mov_b64 exec, s[48:49]
    v_cvt_pk_bf16_f32 v132, v64, v65
    v_cvt_pk_bf16_f32 v133, v66, v67
    v_cvt_pk_bf16_f32 v134, v68, v69
    v_cvt_pk_bf16_f32 v135, v70, v71
    v_cvt_pk_bf16_f32 v136, v72, v73
    v_cvt_pk_bf16_f32 v137, v74, v75
    v_cvt_pk_bf16_f32 v138, v76, v77
    v_cvt_pk_bf16_f32 v139, v78, v79
    s_mov_b64 exec, -1
    v_mfma_f32_32x32x8_bf16 v[16:31], v[122:123], v[84:85], v[16:31]
    ds_read_b128 v[112:115], v162 offset:0
    ds_read_b128 v[116:119], v162 offset:6144
    ds_read_b128 v[120:123], v162 offset:12288
    ds_read_b128 v[80:83], v162 offset:1024
    s_cmp_lg_u32 s43, 0
    s_cbranch_scc1 L_rare0H
L_rare0H_ret:
    v_exp_f32 v0, v0
    v_exp_f32 v1, v1
    v_exp_f32 v2, v2
    v_exp_f32 v3, v3
    v_exp_f32 v4, v4
    v_exp_f32 v5, v5
    v_exp_f32 v6, v6
    v_exp_f32 v7, v7
    v_cvt_pk_bf16_f32 v0, v0, v1
    v_cvt_pk_bf16_f32 v1, v2, v3
    v_cvt_pk_bf16_f32 v2, v4, v5
    v_cvt_pk_bf16_f32 v3, v6, v7
    v_exp_f32 v8, v8
    s_nop 0
    v_mfma_f32_32x32x16_bf16 v[48:63], v[124:127], v[0:3], 0
    v_exp_f32 v9, v9
    v_exp_f32 v10, v10
    v_exp_f32 v11, v11
    v_exp_f32 v12, v12
    v_exp_f32 v13, v13
    v_exp_f32 v14, v14
    v_exp_f32 v15, v15
    v_cvt_pk_bf16_f32 v4, v8, v9
    v_cvt_pk_bf16_f32 v5, v10, v11
    v_cvt_pk_bf16_f32 v6, v12, v13
    v_cvt_pk_bf16_f32 v7, v14, v15
    v_exp_f32 v16, v16
    s_nop 0
    v_mfma_f32_32x32x16_bf16 v[48:63], v[128:131], v[4:7], v[48:63]
    v_exp_f32 v17, v17
    v_exp_f32 v18, v18
    v_exp_f32 v19, v19
    v_exp_f32 v20, v20
    v_exp_f32 v21, v21
    v_exp_f32 v22, v22
    v_exp_f32 v23, v23
    v_cvt_pk_bf16_f32 v16, v16, v17
    v_cvt_pk_bf16_f32 v17, v18, v19
    v_cvt_pk_bf16_f32 v18, v20, v21
    v_cvt_pk_bf16_f32 v19, v22, v23
    v_exp_f32 v24, v24
    s_nop 0
    v_mfma_f32_32x32x16_bf16 v[48:63], v[132:135], v[16:19], v[48:63]
    v_exp_f32 v25, v25
    v_exp_f32 v26, v26
    v_exp_f32 v27, v27
    v_exp_f32 v28, v28
    v_exp_f32 v29, v29
    v_exp_f32 v30, v30
    v_exp_f32 v31, v31
    v_cvt_pk_bf16_f32 v20, v24, v25
    v_cvt_pk_bf16_f32 v21, v26, v27
    v_cvt_pk_bf16_f32 v22, v28, v29
    v_cvt_pk_bf16_f32 v23, v30, v31
    ds_read_b128 v[84:87], v162 offset:7168
    s_nop 0
    v_mfma_f32_32x32x16_bf16 v[48:63], v[136:139], v[20:23], v[48:63]
    s_setprio 0
    s_setprio 0
    ds_read_b128 v[88:91], v162 offset:13312
    ds_read_b128 v[148:151], v162 offset:14336
    ds_read_b128 v[0:3], v162 offset:3072
    ds_read_b128 v[4:7], v162 offset:9216
    s_nop 5
    v_rcp_f32 v166, v60
    ds_read_b128 v[8:11], v162 offset:15360
    v_mul_f32 v48, v48, v166
    v_mul_f32 v49, v49, v166
    v_cvt_pk_bf16_f32 v48, v48, v49
    v_mul_f32 v50, v50, v166
    v_mul_f32 v51, v51, v166
    v_cvt_pk_bf16_f32 v49, v50, v51
    v_mul_f32 v52, v52, v166
    v_mul_f32 v53, v53, v166
    v_cvt_pk_bf16_f32 v50, v52, v53
    v_mul_f32 v54, v54, v166
    v_mul_f32 v55, v55, v166
    v_mul_f32 v56, v56, v166
    v_mul_f32 v57, v57, v166
    v_mul_f32 v58, v58, v166
    v_mul_f32 v59, v59, v166
    v_cvt_pk_bf16_f32 v51, v54, v55
    v_cvt_pk_bf16_f32 v52, v56, v57
    v_cvt_pk_bf16_f32 v53, v58, v59
    ds_write_b64 v157, v[48:49] offset:0
    ds_write_b64 v158, v[50:51] offset:0
    ds_write_b64 v159, v[52:53] offset:0
    s_mov_b64 exec, 1
    v_mov_b32 v163, 1
    ds_add_u32 v161, v163 offset:32
    s_mov_b64 exec, -1
    ds_read_b128 v[12:15], v162 offset:4096
    ds_read_b128 v[16:19], v162 offset:10240
    ds_read_b128 v[20:23], v162 offset:16384
    ds_read_b128 v[24:27], v162 offset:5120
    ds_read_b128 v[28:31], v162 offset:11264
    ds_read_b128 v[32:35], v162 offset:17408
    s_cmp_ge_u32 s33, 2
    s_cbranch_scc1 L_fin
    ds_read_b32 v163, v161 offset:32
    v_mov_b32 v76, 0x3c2aaaab
    s_waitcnt lgkmcnt(0)
    v_readfirstlane_b32 s41, v163
    s_cmp_lt_u32 s41, 4
    s_cbranch_scc1 L_poll6
L_poll6_ok:
    ds_read_b128 v[36:39], v160 offset:0
    ds_read_b128 v[40:43], v160 offset:64
    ds_read_b128 v[44:47], v160 offset:128
    s_mul_i32 s53, s96, 3072
    s_add_u32 s53, s53, s39
    s_sub_u32 s53, s53, 55360
    v_add_u32 v164, s53, v162
    s_waitcnt lgkmcnt(2)
    v_mfma_f32_16x16x32_bf16 v[48:51], v[112:115], v[36:39], 0
    v_mfma_f32_16x16x32_bf16 v[52:55], v[80:83], v[36:39], 0
    s_waitcnt lgkmcnt(1)
    v_mfma_f32_16x16x32_bf16 v[48:51], v[116:119], v[40:43], v[48:51]
    v_mfma_f32_16x16x32_bf16 v[56:59], v[140:143], v[36:39], 0
    v_mfma_f32_16x16x32_bf16 v[52:55], v[84:87], v[40:43], v[52:55]
    v_mfma_f32_16x16x32_bf16 v[60:63], v[0:3], v[36:39], 0
    s_waitcnt lgkmcnt(0)
    v_mfma_f32_16x16x32_bf16 v[48:51], v[120:123], v[44:47], v[48:51]
    v_mfma_f32_16x16x32_bf16 v[56:59], v[144:147], v[40:43], v[56:59]
    v_mfma_f32_16x16x32_bf16 v[64:67], v[12:15], v[36:39], 0
    s_nop 5
    v_mul_f32 v74, v48, v48
    v_mul_f32 v75, v49, v49
    v_mfma_f32_16x16x32_bf16 v[52:55], v[88:91], v[44:47], v[52:55]
    v_fmac_f32 v74, v50, v50
    v_fmac_f32 v75, v51, v51
    v_mfma_f32_16x16x32_bf16 v[60:63], v[4:7], v[40:43], v[60:63]
    v_mfma_f32_16x16x32_bf16 v[68:71], v[24:27], v[36:39], 0
    s_nop 3
    v_fmac_f32 v74, v52, v52
    v_fmac_f32 v75, v53, v53
    v_mfma_f32_16x16x32_bf16 v[56:59], v[148:151], v[44:47], v[56:59]
    v_fmac_f32 v74, v54, v54
    v_fmac_f32 v75, v55, v55
    v_mfma_f32_16x16x32_bf16 v[64:67], v[16:19], v[40:43], v[64:67]
    v_mfma_f32_16x16x32_bf16 v[60:63], v[8:11], v[44:47], v[60:63]
    s_nop 3
    v_fmac_f32 v74, v56, v56
    v_fmac_f32 v75, v57, v57
    v_mfma_f32_16x16x32_bf16 v[68:71], v[28:31], v[40:43], v[68:71]
    v_fmac_f32 v74, v58, v58
    v_fmac_f32 v75, v59, v59
    v_mfma_f32_16x16x32_bf16 v[64:67], v[20:23], v[44:47], v[64:67]
    v_fmac_f32 v74, v60, v60
    v_fmac_f32 v75, v61, v61
    v_mfma_f32_16x16x32_bf16 v[68:71], v[32:35], v[44:47], v[68:71]
    v_fmac_f32 v74, v62, v62
    v_fmac_f32 v75, v63, v63
    s_nop 2
    v_fmac_f32 v74, v64, v64
    v_fmac_f32 v75, v65, v65
    v_fmac_f32 v74, v66, v66
    v_fmac_f32 v75, v67, v67
    v_fmac_f32 v74, v68, v68
    v_fmac_f32 v75, v69, v69
    v_fmac_f32 v74, v70, v70
    v_fmac_f32 v75, v71, v71
    v_add_f32 v74, v74, v75
    s_nop 1
    v_mfma_f32_16x16x4_f32 v[84:87], v76, v74, 0
    s_nop 9
    v_add_f32 v74, 0x3727c5ac, v84
    v_rsq_f32 v74, v74
    s_nop 0
    v_mul_f32 v48, v48, v74
    v_mul_f32 v49, v49, v74
    v_cvt_pk_bf16_f32 v48, v48, v49
    v_mul_f32 v50, v50, v74
    v_mul_f32 v51, v51, v74
    v_cvt_pk_bf16_f32 v49, v50, v51
    v_mul_f32 v52, v52, v74
    v_mul_f32 v53, v53, v74
    v_mul_f32 v54, v54, v74
    v_mul_f32 v55, v55, v74
    v_mul_f32 v56, v56, v74
    v_mul_f32 v57, v57, v74
    v_cvt_pk_bf16_f32 v50, v52, v53
    v_cvt_pk_bf16_f32 v51, v54, v55
    v_cvt_pk_bf16_f32 v56, v56, v57
    v_mul_f32 v58, v58, v74
    v_mul_f32 v59, v59, v74
    ds_write_b128 v160, v[48:51] offset:0
    v_cvt_pk_bf16_f32 v57, v58, v59
    v_mul_f32 v60, v60, v74
    v_mul_f32 v61, v61, v74
    v_mul_f32 v62, v62, v74
    v_mul_f32 v63, v63, v74
    v_mul_f32 v64, v64, v74
    v_mul_f32 v65, v65, v74
    v_cvt_pk_bf16_f32 v58, v60, v61
    v_cvt_pk_bf16_f32 v59, v62, v63
    v_cvt_pk_bf16_f32 v64, v64, v65
    v_mul_f32 v66, v66, v74
    v_mul_f32 v67, v67, v74
    ds_write_b128 v160, v[56:59] offset:64
    v_cvt_pk_bf16_f32 v65, v66, v67
    v_mul_f32 v68, v68, v74
    v_mul_f32 v69, v69, v74
    v_mul_f32 v70, v70, v74
    v_mul_f32 v71, v71, v74
    v_cvt_pk_bf16_f32 v66, v68, v69
    v_cvt_pk_bf16_f32 v67, v70, v71
    ds_write_b128 v160, v[64:67] offset:128
    ds_read_b128 v[0:3], v164 offset:0
    ds_read_b128 v[4:7], v164 offset:1024
    ds_read_b128 v[8:11], v164 offset:2048
    s_waitcnt lgkmcnt(2)
    buffer_store_dwordx4 v[0:3], v154, s[28:31], 0 offen sc0 sc1
    s_waitcnt lgkmcnt(1)
    buffer_store_dwordx4 v[4:7], v155, s[28:31], 0 offen sc0 sc1
    s_waitcnt lgkmcnt(0)
    buffer_store_dwordx4 v[8:11], v156, s[28:31], 0 offen sc0 sc1
    s_branch L_fin
L_BC:
    s_sub_u32 s54, s3, 4
    v_and_b32 v164, 15, v123
    v_lshrrev_b32 v165, 4, v123
    v_mul_u32_u24 v10, 4320, v165
    v_sub_u32 v166, 14, v164
    v_lshl_add_u32 v10, v166, 2, v10
    s_mul_i32 s41, s54, 288
    s_add_u32 s41, s41, 73792
    v_add_u32 v10, s41, v10
    v_lshrrev_b32 v166, 2, v164
    v_lshlrev_b32 v166, 1, v166
    v_lshl_add_u32 v166, v165, 5, v166
    v_add_u32 v100, 144320, v166
    v_lshlrev_b32 v166, 1, v164
    v_add_u32 v101, 144320, v166
    v_lshlrev_b32 v166, 1, v165
    v_add_u32 v102, 144320, v166
    v_min_u32 v166, 14, v164
    s_mul_i32 s41, s54, 15
    v_add_u32 v166, s41, v166
    v_lshlrev_b32 v166, 2, v166
    v_add_u32 v103, 144320, v166
    v_mov_b32 v1, 0
    v_mov_b32 v17, 0
    v_mov_b32 v33, 0
    v_cmp_gt_u32 vcc, 16, v123
    s_cmp_lt_u32 s3, 11
    s_cselect_b64 s[98:99], s[58:59], 0
    s_cmp_eq_u32 s32, 2
    s_cbranch_scc1 L_C1
    s_mov_b32 exec_hi, 0xffff
    s_mul_i32 s42, s33, 2304
    s_mul_i32 s41, s33, 768
    s_add_u32 s53, s42, 0
    s_add_u32 m0, s41, 18496
    s_nop 0
    buffer_load_dwordx4 v108, s[24:27], s53 offen lds
    s_add_u32 s53, s42, 9216
    s_add_u32 m0, s41, 21568
    s_nop 0
    buffer_load_dwordx4 v108, s[24:27], s53 offen lds
    s_add_u32 s53, s42, 18432
    s_add_u32 m0, s41, 24640
    s_nop 0
    buffer_load_dwordx4 v108, s[24:27], s53 offen lds
    s_add_u32 s53, s42, 27648
    s_add_u32 m0, s41, 27712
    s_nop 0
    buffer_load_dwordx4 v108, s[24:27], s53 offen lds
    s_add_u32 s53, s42, 36864
    s_add_u32 m0, s41, 30784
    s_nop 0
    buffer_load_dwordx4 v108, s[24:27], s53 offen lds
    s_add_u32 s53, s42, 46080
    s_add_u32 m0, s41, 33856
    s_nop 0
    buffer_load_dwordx4 v108, s[24:27], s53 offen lds
    s_mul_i32 s42, s33, 2304
    s_mul_i32 s41, s33, 768
    s_add_u32 s53, s42, 384
    s_add_u32 m0, s41, 36928
    s_nop 0
    buffer_load_dwordx4 v108, s[24:27], s53 offen lds
    s_add_u32 s53, s42, 9600
    s_add_u32 m0, s41, 40000
    s_nop 0
    buffer_load_dwordx4 v108, s[24:27], s53 offen lds
    s_add_u32 s53, s42, 18816
    s_add_u32 m0, s41, 43072
    s_nop 0
    buffer_load_dwordx4 v108, s[24:27], s53 offen lds
    s_add_u32 s53, s42, 28032
    s_add_u32 m0, s41, 46144
    s_nop 0
    buffer_load_dwordx4 v108, s[24:27], s53 offen lds
    s_add_u32 s53, s42, 37248
    s_add_u32 m0, s41, 49216
    s_nop 0
    buffer_load_dwordx4 v108, s[24:27], s53 offen lds
    s_add_u32 s53, s42, 46464
    s_add_u32 m0, s41, 52288
    s_nop 0
    buffer_load_dwordx4 v108, s[24:27], s53 offen lds
    s_mul_i32 s41, s33, 3072
    s_add_u32 s41, s41, s39
    s_add_u32 m0, s41, 0
    s_nop 0
    buffer_load_dwordx4 v109, s[20:23], s37 offen nt lds
    v_xor_b32 v165, 48, v109
    s_add_u32 m0, s41, 768
    s_nop 0
    buffer_load_dwordx4 v165, s[20:23], s92 offen nt lds
    v_xor_b32 v164, 32, v109
    s_add_u32 s42, s37, 43008
    s_add_u32 m0, s41, 1536
    s_nop 0
    buffer_load_dwordx4 v164, s[20:23], s42 offen nt lds
    v_xor_b32 v165, 16, v109
    s_add_u32 s42, s92, 43008
    s_add_u32 m0, s41, 2304
    s_nop 0
    buffer_load_dwordx4 v165, s[20:23], s42 offen nt lds
    s_mov_b64 exec, -1
    s_branch L_tab
L_C1:
    s_mul_i32 s41, s33, 6144
    s_add_u32 s41, s41, 55360
    v_lshrrev_b32 v166, 2, v164
    v_lshlrev_b32 v166, 3, v166
    v_and_b32 v167, 3, v164
    v_add_u32 v166, v166, v167
    v_mul_u32_u24 v104, 192, v166
    v_lshl_add_u32 v104, v165, 4, v104
    v_add_u32 v104, s41, v104
    v_bfe_u32 v166, v123, 2, 2
    v_lshl_add_u32 v166, v165, 3, v166
    v_mul_u32_u24 v105, 192, v166
    v_and_b32 v166, 3, v123
    v_lshl_add_u32 v105, v166, 4, v105
    v_add_u32 v105, s41, v105
    v_add_u32 v106, s41, v120
    s_cmp_lg_u32 s33, 0
    s_cbranch_scc1 L_tab
    s_waitcnt vmcnt(0)
L_tab:
    s_waitcnt lgkmcnt(0)
    s_setprio 3
    s_barrier
    ds_read_u16 v0, v101 offset:0
    ds_read_u16 v2, v101 offset:32
    ds_read_b32 v16, v103 offset:208
    ds_read_b32 v32, v103 offset:688
    ds_read_u16 v12, v100 offset:64
    ds_read_u16 v13, v100 offset:72
    ds_read_u16 v14, v100 offset:80
    ds_read_u16 v15, v100 offset:88
    ds_read_u16 v8, v102 offset:192
    s_waitcnt lgkmcnt(7)
    v_lshl_or_b32 v0, v2, 16, v0
    v_cndmask_b32 v0, 0, v0, vcc
    s_waitcnt lgkmcnt(6)
    s_nop 0
    v_mfma_f32_16x16x16_bf16 v[18:21], v[0:1], v[16:17], 0
    s_waitcnt lgkmcnt(5)
    v_mfma_f32_16x16x16_bf16 v[34:37], v[0:1], v[32:33], 0
    s_waitcnt lgkmcnt(3)
    v_lshl_or_b32 v4, v13, 16, v12
    s_nop 3
    v_max_f32 v18, 0, v18
    v_max_f32 v19, 0, v19
    v_max_f32 v20, 0, v20
    v_max_f32 v21, 0, v21
    v_max_f32 v34, 0, v34
    v_max_f32 v35, 0, v35
    v_max_f32 v36, 0, v36
    v_max_f32 v37, 0, v37
    s_waitcnt lgkmcnt(1)
    v_lshl_or_b32 v5, v15, 16, v14
    v_cvt_pk_bf16_f32 v22, v18, v19
    v_cvt_pk_bf16_f32 v23, v20, v21
    v_cvt_pk_bf16_f32 v38, v34, v35
    v_cvt_pk_bf16_f32 v39, v36, v37
    v_mfma_f32_16x16x16_bf16 v[24:27], v[4:5], v[22:23], 0
    s_waitcnt lgkmcnt(0)
    v_lshlrev_b32 v8, 16, v8
    v_min_f32 v166, 0x40930000, v8
    v_mfma_f32_16x16x16_bf16 v[40:43], v[4:5], v[38:39], 0
    v_max_f32 v166, 0xc2c80000, v166
    v_mul_f32 v166, 0x3fb8aa3b, v166
    v_exp_f32 v166, v166
    s_nop 0
    v_cvt_pk_bf16_f32 v28, v24, v24
    v_lshlrev_b32 v28, 16, v28
    v_mul_f32 v28, 0xbfb8aa3b, v28
    s_nop 0
    v_cvt_pk_bf16_f32 v44, v40, v40
    v_lshlrev_b32 v44, 16, v44
    v_mul_f32 v44, 0xbfb8aa3b, v44
    v_exp_f32 v28, v28
    v_exp_f32 v44, v44
    v_add_f32 v28, 1.0, v28
    v_add_f32 v44, 1.0, v44
    v_cvt_pk_bf16_f32 v166, v166, v166
    v_rcp_f32 v28, v28
    v_rcp_f32 v44, v44
    v_lshlrev_b32 v166, 16, v166
    v_mul_f32 v9, 0x3fb8aa3b, v166
    v_cvt_pk_bf16_f32 v28, v28, v28
    v_cvt_pk_bf16_f32 v44, v44, v44
    v_mul_f32 v166, 0x3f80a3d7, v9
    v_add_f32 v166, 0xc1d747ae, v166
    v_lshlrev_b32 v28, 16, v28
    v_lshlrev_b32 v44, 16, v44
    v_max_f32 v8, 0x4138a3d7, v166
    v_mul_f32 v28, 0x41b8aa3b, v28
    v_mul_f32 v44, 0x41b8aa3b, v44
    v_sub_f32 v28, v28, v8
    v_sub_f32 v44, v44, v8
    s_mov_b64 exec, s[58:59]
    ds_write_b32 v10, v28 offset:0
    ds_write_b32 v10, v28 offset:60
    ds_write_b32 v10, v28 offset:120
    ds_write_b32 v10, v28 offset:180
    s_mov_b64 exec, -1
    s_mov_b64 exec, s[98:99]
    ds_write_b32 v10, v44 offset:2304
    ds_write_b32 v10, v44 offset:2364
    ds_write_b32 v10, v44 offset:2424
    ds_write_b32 v10, v44 offset:2484
    s_mov_b64 exec, -1
    s_waitcnt lgkmcnt(0)
    s_cmp_ge_u32 s33, 2
    s_cselect_b32 s41, s51, s50
    s_lshl_b32 s42, s41, 16
    s_and_b32 s41, s41, 0xffff0000
    s_bitcmp1_b32 s33, 0
    s_cselect_b32 s41, s41, s42
    v_mov_b32 v167, s41
    v_min_f32 v167, 0x40930000, v167
    v_max_f32 v167, 0xc2c80000, v167
    v_mul_f32 v167, 0x3fb8aa3b, v167
    v_exp_f32 v167, v167
    s_nop 0
    v_cvt_pk_bf16_f32 v167, v167, v167
    v_lshlrev_b32 v167, 16, v167
    v_mul_f32 v166, 0x3fb8aa3b, v167
    v_cmp_lt_f32 vcc, 0x424ccccd, v166
    v_readfirstlane_b32 s56, v166
    s_cmp_lg_u64 vcc, 0
    s_cselect_b32 s44, 1, 0
    s_cmp_eq_u32 s32, 2
    s_cbranch_scc1 L_C2
    v_and_b32 v166, 31, v123
    v_mul_u32_u24 v164, 192, v166
    v_lshrrev_b32 v167, 1, v166
    v_xor_b32 v167, v167, v166
    v_bfe_u32 v167, v167, 1, 2
    v_lshrrev_b32 v166, 5, v123
    v_xor_b32 v166, v166, v167
    v_lshl_add_u32 v164, v166, 4, v164
    v_add_u32 v164, s39, v164
    v_xor_b32 v165, 32, v164
    s_waitcnt vmcnt(4) lgkmcnt(0)
    s_barrier
    s_branch L_main_B
L_C2:
    s_mov_b32 exec_hi, 0xffff
    s_mul_i32 s41, s33, 3072
    s_add_u32 s41, s41, s39
    s_add_u32 m0, s41, 0
    s_nop 0
    buffer_load_dwordx4 v109, s[20:23], s37 offen nt lds
    v_xor_b32 v165, 48, v109
    s_add_u32 m0, s41, 768
    s_nop 0
    buffer_load_dwordx4 v165, s[20:23], s92 offen nt lds
    v_xor_b32 v164, 32, v109
    s_add_u32 s42, s37, 43008
    s_add_u32 m0, s41, 1536
    s_nop 0
    buffer_load_dwordx4 v164, s[20:23], s42 offen nt lds
    v_xor_b32 v165, 16, v109
    s_add_u32 s42, s92, 43008
    s_add_u32 m0, s41, 2304
    s_nop 0
    buffer_load_dwordx4 v165, s[20:23], s42 offen nt lds
    s_mov_b64 exec, -1
    s_cmp_eq_u32 s33, 3
    s_cbranch_scc1 L_C_nowo
    s_mov_b32 s60, s8
    s_and_b32 s61, s9, 0xffff
    s_mov_b32 s62, 18432
    s_mov_b32 s63, 0x20000
    s_mul_i32 s41, s33, 6144
    s_add_u32 s41, s41, 0
    s_add_u32 m0, s41, 55360
    s_nop 0
    buffer_load_dwordx4 v120, s[60:63], s41 offen lds
    s_mul_i32 s41, s33, 6144
    s_add_u32 s41, s41, 1024
    s_add_u32 m0, s41, 55360
    s_nop 0
    buffer_load_dwordx4 v120, s[60:63], s41 offen lds
    s_mul_i32 s41, s33, 6144
    s_add_u32 s41, s41, 2048
    s_add_u32 m0, s41, 55360
    s_nop 0
    buffer_load_dwordx4 v120, s[60:63], s41 offen lds
    s_mul_i32 s41, s33, 6144
    s_add_u32 s41, s41, 3072
    s_add_u32 m0, s41, 55360
    s_nop 0
    buffer_load_dwordx4 v120, s[60:63], s41 offen lds
    s_mul_i32 s41, s33, 6144
    s_add_u32 s41, s41, 4096
    s_add_u32 m0, s41, 55360
    s_nop 0
    buffer_load_dwordx4 v120, s[60:63], s41 offen lds
    s_mul_i32 s41, s33, 6144
    s_add_u32 s41, s41, 5120
    s_add_u32 m0, s41, 55360
    s_nop 0
    buffer_load_dwordx4 v120, s[60:63], s41 offen lds
L_C_nowo:
    s_waitcnt lgkmcnt(0)
    s_barrier
    s_cmp_eq_u32 s57, 0
    s_cbranch_scc1 L_C_noleft1
    s_mov_b32 exec_hi, 0xffff
    s_lshl_b32 s54, s33, 1
    s_add_u32 s54, s54, 4
    s_mul_i32 s54, s54, 43008
    s_mul_i32 s55, s95, 1536
    s_add_u32 s54, s54, s55
    s_add_u32 s54, s54, 768
    s_add_u32 s55, s54, 768
    s_mov_b32 s53, 127936
    s_mul_i32 s41, s33, 3072
    s_add_u32 s41, s41, s53
    s_add_u32 m0, s41, 0
    s_nop 0
    buffer_load_dwordx4 v109, s[20:23], s54 offen nt lds
    v_xor_b32 v165, 48, v109
    s_add_u32 m0, s41, 768
    s_nop 0
    buffer_load_dwordx4 v165, s[20:23], s55 offen nt lds
    v_xor_b32 v164, 32, v109
    s_add_u32 s42, s54, 43008
    s_add_u32 m0, s41, 1536
    s_nop 0
    buffer_load_dwordx4 v164, s[20:23], s42 offen nt lds
    v_xor_b32 v165, 16, v109
    s_add_u32 s42, s55, 43008
    s_add_u32 m0, s41, 2304
    s_nop 0
    buffer_load_dwordx4 v165, s[20:23], s42 offen nt lds
    s_mov_b64 exec, -1
L_C_noleft1:
    s_cmp_eq_u32 s33, 3
    s_cbranch_scc1 L_C_woready
    s_cmp_eq_u32 s57, 0
    s_cbranch_scc1 L_C_w3
    s_waitcnt vmcnt(4)
    s_branch L_C_w
L_C_w3:
    s_waitcnt vmcnt(0)
L_C_w:
    ds_read_b128 v[0:3], v104 offset:0
    ds_read_b128 v[12:15], v104 offset:768
    ds_read_b128 v[4:7], v104 offset:64
    ds_read_b128 v[16:19], v104 offset:832
    ds_read_b128 v[8:11], v104 offset:128
    ds_read_b128 v[20:23], v104 offset:896
    ds_read_b64_tr_b16 v[36:37], v105 offset:0
    ds_read_b64_tr_b16 v[38:39], v105 offset:768
    ds_read_b64_tr_b16 v[40:41], v105 offset:8
    ds_read_b64_tr_b16 v[42:43], v105 offset:776
    ds_read_b64_tr_b16 v[44:45], v105 offset:64
    ds_read_b64_tr_b16 v[46:47], v105 offset:832
    ds_read_b64_tr_b16 v[48:49], v105 offset:72
    ds_read_b64_tr_b16 v[50:51], v105 offset:840
    ds_read_b64_tr_b16 v[52:53], v105 offset:128
    ds_read_b64_tr_b16 v[54:55], v105 offset:896
    v_mov_b32 v24, 0x3f803f80
    v_mov_b32 v25, 0x3f803f80
    v_mov_b32 v26, 0x3f803f80
    v_mov_b32 v27, 0x3f803f80
    ds_read_b64_tr_b16 v[56:57], v105 offset:136
    s_waitcnt lgkmcnt(14)
    v_mfma_f32_16x16x32_bf16 v[28:31], v[0:3], v[24:27], 0
    ds_read_b64_tr_b16 v[58:59], v105 offset:904
    v_mfma_f32_16x16x32_bf16 v[32:35], v[12:15], v[24:27], 0
    s_waitcnt lgkmcnt(11)
    v_lshlrev_b32 v60, 16, v36
    v_and_b32 v61, 0xffff0000, v36
    v_mfma_f32_16x16x32_bf16 v[28:31], v[4:7], v[24:27], v[28:31]
    v_lshlrev_b32 v62, 16, v37
    v_and_b32 v63, 0xffff0000, v37
    v_mfma_f32_16x16x32_bf16 v[32:35], v[16:19], v[24:27], v[32:35]
    s_waitcnt lgkmcnt(10)
    v_lshlrev_b32 v64, 16, v38
    v_and_b32 v65, 0xffff0000, v38
    v_mfma_f32_16x16x32_bf16 v[28:31], v[8:11], v[24:27], v[28:31]
    v_lshlrev_b32 v66, 16, v39
    v_and_b32 v67, 0xffff0000, v39
    v_mfma_f32_16x16x32_bf16 v[32:35], v[20:23], v[24:27], v[32:35]
    s_waitcnt lgkmcnt(9)
    v_lshlrev_b32 v68, 16, v40
    v_and_b32 v69, 0xffff0000, v40
    v_lshlrev_b32 v70, 16, v41
    s_nop 0
    v_mul_f32 v28, 0x3c2aaaab, v28
    v_mul_f32 v29, 0x3c2aaaab, v29
    v_mul_f32 v30, 0x3c2aaaab, v30
    v_mul_f32 v31, 0x3c2aaaab, v31
    v_mul_f32 v32, 0x3c2aaaab, v32
    v_mul_f32 v33, 0x3c2aaaab, v33
    v_mul_f32 v34, 0x3c2aaaab, v34
    v_mul_f32 v35, 0x3c2aaaab, v35
    v_sub_f32 v60, v60, v28
    v_sub_f32 v61, v61, v29
    v_sub_f32 v62, v62, v30
    v_sub_f32 v63, v63, v31
    v_sub_f32 v64, v64, v32
    v_sub_f32 v65, v65, v33
    v_sub_f32 v66, v66, v34
    v_sub_f32 v67, v67, v35
    v_cvt_pk_bf16_f32 v36, v60, v61
    v_cvt_pk_bf16_f32 v37, v62, v63
    v_cvt_pk_bf16_f32 v38, v64, v65
    v_cvt_pk_bf16_f32 v39, v66, v67
    v_and_b32 v71, 0xffff0000, v41
    s_waitcnt lgkmcnt(8)
    v_lshlrev_b32 v72, 16, v42
    v_and_b32 v73, 0xffff0000, v42
    v_lshlrev_b32 v74, 16, v43
    v_and_b32 v75, 0xffff0000, v43
    ds_write_b128 v106, v[36:39] offset:0
    v_sub_f32 v68, v68, v28
    v_sub_f32 v69, v69, v29
    v_sub_f32 v70, v70, v30
    v_sub_f32 v71, v71, v31
    v_sub_f32 v72, v72, v32
    v_sub_f32 v73, v73, v33
    v_sub_f32 v74, v74, v34
    v_sub_f32 v75, v75, v35
    v_cvt_pk_bf16_f32 v40, v68, v69
    v_cvt_pk_bf16_f32 v41, v70, v71
    v_cvt_pk_bf16_f32 v42, v72, v73
    v_cvt_pk_bf16_f32 v43, v74, v75
    s_waitcnt lgkmcnt(8)
    v_lshlrev_b32 v60, 16, v44
    v_and_b32 v61, 0xffff0000, v44
    v_lshlrev_b32 v62, 16, v45
    v_and_b32 v63, 0xffff0000, v45
    s_waitcnt lgkmcnt(7)
    v_lshlrev_b32 v64, 16, v46
    v_and_b32 v65, 0xffff0000, v46
    v_lshlrev_b32 v66, 16, v47
    v_and_b32 v67, 0xffff0000, v47
    ds_write_b128 v106, v[40:43] offset:1024
    v_sub_f32 v60, v60, v28
    v_sub_f32 v61, v61, v29
    v_sub_f32 v62, v62, v30
    v_sub_f32 v63, v63, v31
    v_sub_f32 v64, v64, v32
    v_sub_f32 v65, v65, v33
    v_sub_f32 v66, v66, v34
    v_sub_f32 v67, v67, v35
    v_cvt_pk_bf16_f32 v44, v60, v61
    v_cvt_pk_bf16_f32 v45, v62, v63
    v_cvt_pk_bf16_f32 v46, v64, v65
    v_cvt_pk_bf16_f32 v47, v66, v67
    s_waitcnt lgkmcnt(7)
    v_lshlrev_b32 v68, 16, v48
    v_and_b32 v69, 0xffff0000, v48
    v_lshlrev_b32 v70, 16, v49
    v_and_b32 v71, 0xffff0000, v49
    s_waitcnt lgkmcnt(6)
    v_lshlrev_b32 v72, 16, v50
    v_and_b32 v73, 0xffff0000, v50
    v_lshlrev_b32 v74, 16, v51
    v_and_b32 v75, 0xffff0000, v51
    ds_write_b128 v106, v[44:47] offset:2048
    v_sub_f32 v68, v68, v28
    v_sub_f32 v69, v69, v29
    v_sub_f32 v70, v70, v30
    v_sub_f32 v71, v71, v31
    v_sub_f32 v72, v72, v32
    v_sub_f32 v73, v73, v33
    v_sub_f32 v74, v74, v34
    v_sub_f32 v75, v75, v35
    v_cvt_pk_bf16_f32 v48, v68, v69
    v_cvt_pk_bf16_f32 v49, v70, v71
    v_cvt_pk_bf16_f32 v50, v72, v73
    v_cvt_pk_bf16_f32 v51, v74, v75
    s_waitcnt lgkmcnt(6)
    v_lshlrev_b32 v60, 16, v52
    v_and_b32 v61, 0xffff0000, v52
    v_lshlrev_b32 v62, 16, v53
    v_and_b32 v63, 0xffff0000, v53
    s_waitcnt lgkmcnt(5)
    v_lshlrev_b32 v64, 16, v54
    v_and_b32 v65, 0xffff0000, v54
    v_lshlrev_b32 v66, 16, v55
    v_and_b32 v67, 0xffff0000, v55
    ds_write_b128 v106, v[48:51] offset:3072
    v_sub_f32 v60, v60, v28
    v_sub_f32 v61, v61, v29
    v_sub_f32 v62, v62, v30
    v_sub_f32 v63, v63, v31
    v_sub_f32 v64, v64, v32
    v_sub_f32 v65, v65, v33
    v_sub_f32 v66, v66, v34
    v_sub_f32 v67, v67, v35
    v_cvt_pk_bf16_f32 v52, v60, v61
    v_cvt_pk_bf16_f32 v53, v62, v63
    v_cvt_pk_bf16_f32 v54, v64, v65
    v_cvt_pk_bf16_f32 v55, v66, v67
    s_waitcnt lgkmcnt(5)
    v_lshlrev_b32 v68, 16, v56
    v_and_b32 v69, 0xffff0000, v56
    v_lshlrev_b32 v70, 16, v57
    v_and_b32 v71, 0xffff0000, v57
    s_waitcnt lgkmcnt(4)
    v_lshlrev_b32 v72, 16, v58
    v_and_b32 v73, 0xffff0000, v58
    v_lshlrev_b32 v74, 16, v59
    v_and_b32 v75, 0xffff0000, v59
    ds_write_b128 v106, v[52:55] offset:4096
    v_sub_f32 v68, v68, v28
    v_sub_f32 v69, v69, v29
    v_sub_f32 v70, v70, v30
    v_sub_f32 v71, v71, v31
    v_sub_f32 v72, v72, v32
    v_sub_f32 v73, v73, v33
    v_sub_f32 v74, v74, v34
    v_sub_f32 v75, v75, v35
    v_cvt_pk_bf16_f32 v56, v68, v69
    v_cvt_pk_bf16_f32 v57, v70, v71
    v_cvt_pk_bf16_f32 v58, v72, v73
    v_cvt_pk_bf16_f32 v59, v74, v75
    ds_write_b128 v106, v[56:59] offset:5120
L_C_woready:
    s_mov_b64 exec, 1
    v_mov_b32 v163, 1
    v_mov_b32 v167, 0
    ds_add_u32 v167, v163 offset:48
    s_mov_b64 exec, -1
    v_and_b32 v166, 31, v123
    v_mul_u32_u24 v164, 192, v166
    v_lshrrev_b32 v167, 1, v166
    v_xor_b32 v167, v167, v166
    v_bfe_u32 v167, v167, 1, 2
    v_lshrrev_b32 v166, 5, v123
    v_xor_b32 v166, v166, v167
    v_lshl_add_u32 v164, v166, 4, v164
    v_add_u32 v164, s39, v164
    v_xor_b32 v165, 32, v164
L_main_B:
    s_or_b32 s43, s45, s46
    s_or_b32 s43, s43, s44
    s_setprio 2
    ds_read_b64_tr_b16 v[80:81], v152 offset:0
    ds_read_b64_tr_b16 v[82:83], v152 offset:768
    ds_read_b64_tr_b16 v[84:85], v152 offset:3072
    ds_read_b64_tr_b16 v[86:87], v152 offset:3840
    ds_read_b64_tr_b16 v[88:89], v152 offset:6144
    ds_read_b64_tr_b16 v[90:91], v152 offset:6912
    ds_read_b64_tr_b16 v[92:93], v152 offset:9216
    ds_read_b64_tr_b16 v[94:95], v152 offset:9984
    ds_read_b64_tr_b16 v[96:97], v152 offset:12288
    ds_read_b64_tr_b16 v[98:99], v152 offset:13056
    ds_read_b64_tr_b16 v[100:101], v152 offset:15360
    ds_read_b64_tr_b16 v[102:103], v152 offset:16128
    s_waitcnt vmcnt(0)
    s_mov_b64 exec, 1
    v_mov_b32 v163, 1
    ds_add_u32 v161, v163 offset:0
    s_mov_b64 exec, -1
    s_cmp_eq_u32 s97, 0
    s_cbranch_scc1 L_nox3
    s_mov_b64 exec, 1
    v_mov_b32 v163, 1
    v_mov_b32 v167, 12
    ds_add_u32 v167, v163 offset:0
    s_mov_b64 exec, -1
L_nox3:
    ds_read_b32 v163, v161 offset:0
    s_waitcnt lgkmcnt(0)
    v_readfirstlane_b32 s41, v163
    s_cmp_lt_u32 s41, 4
    s_cbranch_scc1 L_poll7
L_poll7_ok:
    ds_read_b128 v[0:3], v164 offset:0
    ds_read_b128 v[4:7], v164 offset:6144
    ds_read_b128 v[8:11], v165 offset:0
    ds_read_b128 v[12:15], v165 offset:6144
    ds_read_b128 v[16:19], v164 offset:64
    ds_read_b128 v[20:23], v164 offset:6208
    ds_read_b128 v[24:27], v165 offset:64
    ds_read_b128 v[28:31], v165 offset:6208
    ds_read_b128 v[32:35], v164 offset:128
    ds_read_b128 v[36:39], v164 offset:6272
    ds_read_b128 v[40:43], v165 offset:128
    ds_read_b128 v[44:47], v165 offset:6272
    s_waitcnt lgkmcnt(11)
    v_mfma_f32_32x32x16_bf16 v[48:63], v[80:83], v[0:3], 0
    s_waitcnt lgkmcnt(10)
    v_mfma_f32_32x32x16_bf16 v[64:79], v[80:83], v[4:7], 0
    s_waitcnt lgkmcnt(9)
    v_mfma_f32_32x32x16_bf16 v[48:63], v[84:87], v[8:11], v[48:63]
    s_waitcnt lgkmcnt(8)
    v_mfma_f32_32x32x16_bf16 v[64:79], v[84:87], v[12:15], v[64:79]
    s_waitcnt lgkmcnt(7)
    v_mfma_f32_32x32x16_bf16 v[48:63], v[88:91], v[16:19], v[48:63]
    s_waitcnt lgkmcnt(6)
    v_mfma_f32_32x32x16_bf16 v[64:79], v[88:91], v[20:23], v[64:79]
    s_waitcnt lgkmcnt(5)
    v_mfma_f32_32x32x16_bf16 v[48:63], v[92:95], v[24:27], v[48:63]
    s_waitcnt lgkmcnt(4)
    v_mfma_f32_32x32x16_bf16 v[64:79], v[92:95], v[28:31], v[64:79]
    s_waitcnt lgkmcnt(3)
    v_mfma_f32_32x32x16_bf16 v[48:63], v[96:99], v[32:35], v[48:63]
    s_waitcnt lgkmcnt(2)
    v_mfma_f32_32x32x16_bf16 v[64:79], v[96:99], v[36:39], v[64:79]
    s_waitcnt lgkmcnt(1)
    v_mfma_f32_32x32x16_bf16 v[48:63], v[100:103], v[40:43], v[48:63]
    s_waitcnt lgkmcnt(0)
    v_mfma_f32_32x32x16_bf16 v[64:79], v[100:103], v[44:47], v[64:79]
    s_branch L_rest
L_Cload:
    s_setprio 3
    s_cmp_eq_u32 s33, 0
    s_cbranch_scc1 L_C_small
    s_cmp_eq_u32 s33, 3
    s_cbranch_scc0 L_C_nopf
    s_lshr_b32 s41, s2, 3
    s_mul_i32 s41, s41, 18
    v_add_u32 v164, s41, v123
    v_lshlrev_b32 v164, 7, v164
    v_cmp_gt_u32 vcc, 18, v123
    v_mov_b32 v165, 0x7fffffff
    s_nop 0
    v_cndmask_b32 v164, v165, v164, vcc
    v_subrev_u32 v165, 55296, v164
    s_waitcnt lgkmcnt(0)
    s_mov_b32 s24, s6
    s_and_b32 s25, s7, 0xffff
    s_mov_b32 s26, 55296
    s_mov_b32 s27, 0x20000
    s_mov_b32 s60, s8
    s_and_b32 s61, s9, 0xffff
    s_mov_b32 s62, 18432
    s_mov_b32 s63, 0x20000
    buffer_load_dword v143, v164, s[24:27], 0 offen
    buffer_load_dword v144, v165, s[60:63], 0 offen
    s_getpc_b64 s[60:61]
L_pc:
    s_sub_u32 s60, s60, L_pc-standalone__window_attn_swin_v2__vision_kernel
    s_subb_u32 s61, s61, 0
    v_lshlrev_b32 v164, 7, v123
    v_add_u32 v165, 0, v164
    v_min_u32 v165, L_code_end-standalone__window_attn_swin_v2__vision_kernel-4, v165
    global_load_dword v140, v165, s[60:61]
    v_add_u32 v165, 8192, v164
    v_min_u32 v165, L_code_end-standalone__window_attn_swin_v2__vision_kernel-4, v165
    global_load_dword v141, v165, s[60:61]
L_C_nopf:
    s_setprio 0
    s_branch L_common
L_C_small:
    s_mov_b32 s53, 144320
    v_lshlrev_b32 v164, 2, v123
    v_lshlrev_b32 v120, 4, v123
    s_add_u32 m0, s53, 64
    s_waitcnt lgkmcnt(0)
    s_mov_b32 exec_hi, 0
    global_load_lds_dword v164, s[14:15]
    s_add_u32 m0, s53, 0
    s_mov_b64 exec, 0xffff
    global_load_lds_dword v164, s[12:13]
    s_add_u32 m0, s53, 192
    s_mov_b64 exec, 3
    global_load_lds_dword v164, s[10:11]
    s_mov_b32 s60, s16
    s_and_b32 s61, s17, 0xffff
    s_mov_b32 s62, 900
    s_mov_b32 s63, 0x20000
    s_add_u32 m0, s53, 208
    s_mov_b32 exec_lo, -1
    s_mov_b32 exec_hi, 0x01ffffff
    buffer_load_dwordx4 v120, s[60:63], 0 offen lds
    s_mov_b64 exec, -1
    s_setprio 0
    s_branch L_common
L_fin:
L_end:
    s_endpgm
L_rare0N:
    s_nop 15
    s_or_b32 s41, s45, s46
    s_cmp_eq_u32 s41, 0
    s_cbranch_scc1 L_rare0N_nomask
    v_mbcnt_lo_u32_b32 v95, -1, 0
    v_mbcnt_hi_u32_b32 v95, -1, v95
    v_bfe_u32 v94, v95, 2, 1
    v_lshrrev_b32 v95, 5, v95
    v_xor_b32 v94, v94, v95
    v_and_b32 v94, s46, v94
    v_cvt_f32_u32 v94, v94
    v_mul_f32 v94, 0xc31044fe, v94
    s_cmp_lg_u32 s45, 0
    s_cselect_b64 s[50:51], -1, 0
    v_mov_b32 v95, 0xc31044fe
    v_cndmask_b32_e64 v95, v94, v95, s[50:51]
    v_add_f32 v0, v0, v94
    v_add_f32 v16, v16, v95
    v_add_f32 v1, v1, v94
    v_add_f32 v17, v17, v95
    v_add_f32 v2, v2, v94
    v_add_f32 v18, v18, v95
    v_add_f32 v3, v3, v94
    v_add_f32 v19, v19, v95
    v_add_f32 v4, v4, v94
    v_add_f32 v20, v20, v95
    v_add_f32 v5, v5, v94
    v_add_f32 v21, v21, v95
    v_add_f32 v6, v6, v94
    v_add_f32 v22, v22, v95
    v_add_f32 v7, v7, v94
    v_add_f32 v23, v23, v95
    v_add_f32 v8, v8, v94
    v_add_f32 v24, v24, v95
    v_add_f32 v9, v9, v94
    v_add_f32 v25, v25, v95
    v_add_f32 v10, v10, v94
    v_add_f32 v26, v26, v95
    v_add_f32 v11, v11, v94
    v_add_f32 v27, v27, v95
    v_add_f32 v12, v12, v94
    v_add_f32 v28, v28, v95
    v_add_f32 v13, v13, v94
    v_add_f32 v29, v29, v95
    v_add_f32 v14, v14, v94
    v_add_f32 v30, v30, v95
    v_add_f32 v15, v15, v94
    v_add_f32 v31, v31, v95
L_rare0N_nomask:
    s_cmp_eq_u32 s44, 0
    s_cbranch_scc1 L_rare0N_nosafe
    v_max3_f32 v94, v0, v1, v16
    v_max3_f32 v95, v17, v2, v18
    v_max3_f32 v94, v94, v3, v19
    v_max3_f32 v95, v95, v4, v20
    v_max3_f32 v94, v94, v5, v21
    v_max3_f32 v95, v95, v6, v22
    v_max3_f32 v94, v94, v7, v23
    v_max3_f32 v95, v95, v8, v24
    v_max3_f32 v94, v94, v9, v25
    v_max3_f32 v95, v95, v10, v26
    v_max3_f32 v94, v94, v11, v27
    v_max3_f32 v95, v95, v12, v28
    v_max3_f32 v94, v94, v13, v29
    v_max3_f32 v95, v95, v14, v30
    v_max3_f32 v94, v94, v15, v31
    v_max_f32 v94, v94, v95
    v_mov_b32 v95, v94
    s_nop 1
    v_permlane32_swap_b32 v94, v95
    v_max_f32 v94, v94, v95
    v_sub_f32 v0, v0, v94
    v_sub_f32 v16, v16, v94
    v_sub_f32 v1, v1, v94
    v_sub_f32 v17, v17, v94
    v_sub_f32 v2, v2, v94
    v_sub_f32 v18, v18, v94
    v_sub_f32 v3, v3, v94
    v_sub_f32 v19, v19, v94
    v_sub_f32 v4, v4, v94
    v_sub_f32 v20, v20, v94
    v_sub_f32 v5, v5, v94
    v_sub_f32 v21, v21, v94
    v_sub_f32 v6, v6, v94
    v_sub_f32 v22, v22, v94
    v_sub_f32 v7, v7, v94
    v_sub_f32 v23, v23, v94
    v_sub_f32 v8, v8, v94
    v_sub_f32 v24, v24, v94
    v_sub_f32 v9, v9, v94
    v_sub_f32 v25, v25, v94
    v_sub_f32 v10, v10, v94
    v_sub_f32 v26, v26, v94
    v_sub_f32 v11, v11, v94
    v_sub_f32 v27, v27, v94
    v_sub_f32 v12, v12, v94
    v_sub_f32 v28, v28, v94
    v_sub_f32 v13, v13, v94
    v_sub_f32 v29, v29, v94
    v_sub_f32 v14, v14, v94
    v_sub_f32 v30, v30, v94
    v_sub_f32 v15, v15, v94
    v_sub_f32 v31, v31, v94
L_rare0N_nosafe:
    s_nop 1
    s_branch L_rare0N_ret
L_rare1N:
    s_nop 15
    s_or_b32 s41, s45, s46
    s_cmp_eq_u32 s41, 0
    s_cbranch_scc1 L_rare1N_nomask
    v_mbcnt_lo_u32_b32 v95, -1, 0
    v_mbcnt_hi_u32_b32 v95, -1, v95
    v_bfe_u32 v94, v95, 2, 1
    v_lshrrev_b32 v95, 5, v95
    v_xor_b32 v94, v94, v95
    v_and_b32 v94, s46, v94
    v_cvt_f32_u32 v94, v94
    v_mul_f32 v94, 0xc31044fe, v94
    s_cmp_lg_u32 s45, 0
    s_cselect_b64 s[50:51], -1, 0
    v_mov_b32 v95, 0xc31044fe
    v_cndmask_b32_e64 v95, v94, v95, s[50:51]
    v_add_f32 v96, v96, v94
    v_add_f32 v32, v32, v95
    v_add_f32 v97, v97, v94
    v_add_f32 v33, v33, v95
    v_add_f32 v98, v98, v94
    v_add_f32 v34, v34, v95
    v_add_f32 v99, v99, v94
    v_add_f32 v35, v35, v95
    v_add_f32 v100, v100, v94
    v_add_f32 v36, v36, v95
    v_add_f32 v101, v101, v94
    v_add_f32 v37, v37, v95
    v_add_f32 v102, v102, v94
    v_add_f32 v38, v38, v95
    v_add_f32 v103, v103, v94
    v_add_f32 v39, v39, v95
    v_add_f32 v104, v104, v94
    v_add_f32 v40, v40, v95
    v_add_f32 v105, v105, v94
    v_add_f32 v41, v41, v95
    v_add_f32 v106, v106, v94
    v_add_f32 v42, v42, v95
    v_add_f32 v107, v107, v94
    v_add_f32 v43, v43, v95
    v_add_f32 v108, v108, v94
    v_add_f32 v44, v44, v95
    v_add_f32 v109, v109, v94
    v_add_f32 v45, v45, v95
    v_add_f32 v110, v110, v94
    v_add_f32 v46, v46, v95
    v_add_f32 v111, v111, v94
    v_add_f32 v47, v47, v95
L_rare1N_nomask:
    s_cmp_eq_u32 s44, 0
    s_cbranch_scc1 L_rare1N_nosafe
    v_max3_f32 v94, v32, v33, v96
    v_max3_f32 v95, v97, v34, v98
    v_max3_f32 v94, v94, v35, v99
    v_max3_f32 v95, v95, v36, v100
    v_max3_f32 v94, v94, v37, v101
    v_max3_f32 v95, v95, v38, v102
    v_max3_f32 v94, v94, v39, v103
    v_max3_f32 v95, v95, v40, v104
    v_max3_f32 v94, v94, v41, v105
    v_max3_f32 v95, v95, v42, v106
    v_max3_f32 v94, v94, v43, v107
    v_max3_f32 v95, v95, v44, v108
    v_max3_f32 v94, v94, v45, v109
    v_max3_f32 v95, v95, v46, v110
    v_max3_f32 v94, v94, v47, v111
    v_max_f32 v94, v94, v95
    v_mov_b32 v95, v94
    s_nop 1
    v_permlane32_swap_b32 v94, v95
    v_max_f32 v94, v94, v95
    v_sub_f32 v32, v32, v94
    v_sub_f32 v96, v96, v94
    v_sub_f32 v33, v33, v94
    v_sub_f32 v97, v97, v94
    v_sub_f32 v34, v34, v94
    v_sub_f32 v98, v98, v94
    v_sub_f32 v35, v35, v94
    v_sub_f32 v99, v99, v94
    v_sub_f32 v36, v36, v94
    v_sub_f32 v100, v100, v94
    v_sub_f32 v37, v37, v94
    v_sub_f32 v101, v101, v94
    v_sub_f32 v38, v38, v94
    v_sub_f32 v102, v102, v94
    v_sub_f32 v39, v39, v94
    v_sub_f32 v103, v103, v94
    v_sub_f32 v40, v40, v94
    v_sub_f32 v104, v104, v94
    v_sub_f32 v41, v41, v94
    v_sub_f32 v105, v105, v94
    v_sub_f32 v42, v42, v94
    v_sub_f32 v106, v106, v94
    v_sub_f32 v43, v43, v94
    v_sub_f32 v107, v107, v94
    v_sub_f32 v44, v44, v94
    v_sub_f32 v108, v108, v94
    v_sub_f32 v45, v45, v94
    v_sub_f32 v109, v109, v94
    v_sub_f32 v46, v46, v94
    v_sub_f32 v110, v110, v94
    v_sub_f32 v47, v47, v94
    v_sub_f32 v111, v111, v94
L_rare1N_nosafe:
    s_nop 1
    s_branch L_rare1N_ret
L_rare0H:
    s_nop 15
    s_or_b32 s41, s45, s46
    s_cmp_eq_u32 s41, 0
    s_cbranch_scc1 L_rare0H_nomask
    v_mbcnt_lo_u32_b32 v95, -1, 0
    v_mbcnt_hi_u32_b32 v95, -1, v95
    v_bfe_u32 v94, v95, 2, 1
    v_lshrrev_b32 v95, 5, v95
    v_xor_b32 v94, v94, v95
    v_and_b32 v94, s46, v94
    v_cvt_f32_u32 v94, v94
    v_mul_f32 v94, 0xc31044fe, v94
    s_cmp_lg_u32 s45, 0
    s_cselect_b64 s[50:51], -1, 0
    v_mov_b32 v95, 0xc31044fe
    v_cndmask_b32_e64 v95, v94, v95, s[50:51]
    v_add_f32 v0, v0, v94
    v_add_f32 v16, v16, v95
    v_add_f32 v1, v1, v94
    v_add_f32 v17, v17, v95
    v_add_f32 v2, v2, v94
    v_add_f32 v18, v18, v95
    v_add_f32 v3, v3, v94
    v_add_f32 v19, v19, v95
    v_add_f32 v4, v4, v94
    v_add_f32 v20, v20, v95
    v_add_f32 v5, v5, v94
    v_add_f32 v21, v21, v95
    v_add_f32 v6, v6, v94
    v_add_f32 v22, v22, v95
    v_add_f32 v7, v7, v94
    v_add_f32 v23, v23, v95
    v_add_f32 v8, v8, v94
    v_add_f32 v24, v24, v95
    v_add_f32 v9, v9, v94
    v_add_f32 v25, v25, v95
    v_add_f32 v10, v10, v94
    v_add_f32 v26, v26, v95
    v_add_f32 v11, v11, v94
    v_add_f32 v27, v27, v95
    v_add_f32 v12, v12, v94
    v_add_f32 v28, v28, v95
    v_add_f32 v13, v13, v94
    v_add_f32 v29, v29, v95
    v_add_f32 v14, v14, v94
    v_add_f32 v30, v30, v95
    v_add_f32 v15, v15, v94
    v_add_f32 v31, v31, v95
L_rare0H_nomask:
    s_cmp_eq_u32 s44, 0
    s_cbranch_scc1 L_rare0H_nosafe
    v_max3_f32 v94, v0, v1, v16
    v_max3_f32 v95, v17, v2, v18
    v_max3_f32 v94, v94, v3, v19
    v_max3_f32 v95, v95, v4, v20
    v_max3_f32 v94, v94, v5, v21
    v_max3_f32 v95, v95, v6, v22
    v_max3_f32 v94, v94, v7, v23
    v_max3_f32 v95, v95, v8, v24
    v_max3_f32 v94, v94, v9, v25
    v_max3_f32 v95, v95, v10, v26
    v_max3_f32 v94, v94, v11, v27
    v_max3_f32 v95, v95, v12, v28
    v_max3_f32 v94, v94, v13, v29
    v_max3_f32 v95, v95, v14, v30
    v_max3_f32 v94, v94, v15, v31
    v_max_f32 v94, v94, v95
    v_mov_b32 v95, v94
    s_nop 1
    v_permlane32_swap_b32 v94, v95
    v_max_f32 v94, v94, v95
    v_sub_f32 v0, v0, v94
    v_sub_f32 v16, v16, v94
    v_sub_f32 v1, v1, v94
    v_sub_f32 v17, v17, v94
    v_sub_f32 v2, v2, v94
    v_sub_f32 v18, v18, v94
    v_sub_f32 v3, v3, v94
    v_sub_f32 v19, v19, v94
    v_sub_f32 v4, v4, v94
    v_sub_f32 v20, v20, v94
    v_sub_f32 v5, v5, v94
    v_sub_f32 v21, v21, v94
    v_sub_f32 v6, v6, v94
    v_sub_f32 v22, v22, v94
    v_sub_f32 v7, v7, v94
    v_sub_f32 v23, v23, v94
    v_sub_f32 v8, v8, v94
    v_sub_f32 v24, v24, v94
    v_sub_f32 v9, v9, v94
    v_sub_f32 v25, v25, v94
    v_sub_f32 v10, v10, v94
    v_sub_f32 v26, v26, v94
    v_sub_f32 v11, v11, v94
    v_sub_f32 v27, v27, v94
    v_sub_f32 v12, v12, v94
    v_sub_f32 v28, v28, v94
    v_sub_f32 v13, v13, v94
    v_sub_f32 v29, v29, v94
    v_sub_f32 v14, v14, v94
    v_sub_f32 v30, v30, v94
    v_sub_f32 v15, v15, v94
    v_sub_f32 v31, v31, v94
L_rare0H_nosafe:
    s_nop 1
    s_branch L_rare0H_ret
L_poll1:
    s_mov_b32 s42, 0x100000
L_poll1_l:
    s_sleep 1
    ds_read_b32 v163, v161 offset:16
    s_waitcnt lgkmcnt(0)
    v_readfirstlane_b32 s41, v163
    s_cmp_ge_u32 s41, 4
    s_cbranch_scc1 L_poll1_ok
    s_sub_u32 s42, s42, 1
    s_cmp_lg_u32 s42, 0
    s_cbranch_scc1 L_poll1_l
    s_branch L_poll1_ok
L_poll2:
    s_mov_b32 s42, 0x100000
L_poll2_l:
    s_sleep 1
    v_mov_b32 v163, 0
    ds_read_b32 v163, v163 offset:48
    s_waitcnt lgkmcnt(0)
    v_readfirstlane_b32 s41, v163
    s_cmp_ge_u32 s41, 4
    s_cbranch_scc1 L_poll2_ok
    s_sub_u32 s42, s42, 1
    s_cmp_lg_u32 s42, 0
    s_cbranch_scc1 L_poll2_l
    s_branch L_poll2_ok
L_poll3:
    s_mov_b32 s42, 0x100000
L_poll3_l:
    ds_read_b32 v163, v161 offset:32
    s_waitcnt lgkmcnt(0)
    v_readfirstlane_b32 s41, v163
    s_cmp_ge_u32 s41, 4
    s_cbranch_scc1 L_poll3_ok
    s_sub_u32 s42, s42, 1
    s_cmp_lg_u32 s42, 0
    s_cbranch_scc1 L_poll3_l
    s_branch L_poll3_ok
L_poll4:
    s_mov_b32 s42, 0x100000
L_poll4_l:
    s_sleep 1
    ds_read_b32 v163, v161 offset:0
    s_waitcnt lgkmcnt(0)
    v_readfirstlane_b32 s41, v163
    s_cmp_ge_u32 s41, 4
    s_cbranch_scc1 L_poll4_ok
    s_sub_u32 s42, s42, 1
    s_cmp_lg_u32 s42, 0
    s_cbranch_scc1 L_poll4_l
    s_branch L_poll4_ok
L_poll5:
    s_mov_b32 s42, 0x100000
L_poll5_l:
    s_sleep 1
    ds_read_b32 v163, v161 offset:16
    s_waitcnt lgkmcnt(0)
    v_readfirstlane_b32 s41, v163
    s_cmp_ge_u32 s41, 4
    s_cbranch_scc1 L_poll5_ok
    s_sub_u32 s42, s42, 1
    s_cmp_lg_u32 s42, 0
    s_cbranch_scc1 L_poll5_l
    s_branch L_poll5_ok
L_poll6:
    s_mov_b32 s42, 0x100000
L_poll6_l:
    ds_read_b32 v163, v161 offset:32
    s_waitcnt lgkmcnt(0)
    v_readfirstlane_b32 s41, v163
    s_cmp_ge_u32 s41, 4
    s_cbranch_scc1 L_poll6_ok
    s_sub_u32 s42, s42, 1
    s_cmp_lg_u32 s42, 0
    s_cbranch_scc1 L_poll6_l
    s_branch L_poll6_ok
L_poll7:
    s_mov_b32 s42, 0x100000
L_poll7_l:
    s_sleep 1
    ds_read_b32 v163, v161 offset:0
    s_waitcnt lgkmcnt(0)
    v_readfirstlane_b32 s41, v163
    s_cmp_ge_u32 s41, 4
    s_cbranch_scc1 L_poll7_ok
    s_sub_u32 s42, s42, 1
    s_cmp_lg_u32 s42, 0
    s_cbranch_scc1 L_poll7_l
    s_branch L_poll7_ok
L_code_end:
.section .rodata,"a"
.p2align 6
.amdhsa_kernel standalone__window_attn_swin_v2__vision_kernel
  .amdhsa_next_free_vgpr 168
  .amdhsa_next_free_sgpr 102
  .amdhsa_accum_offset 168
  .amdhsa_group_segment_fixed_size 0
  .amdhsa_kernarg_size 96
  .amdhsa_user_sgpr_count 2
  .amdhsa_user_sgpr_kernarg_segment_ptr 1
  .amdhsa_system_sgpr_workgroup_id_x 1
.end_amdhsa_kernel
```
